```python
import torch

def _softmax(x, axis=-1):
    return torch.softmax(x, dim=axis)
def _gelu(x):
    return torch.nn.functional.gelu(x, approximate="tanh")
def _silu(x):
    return torch.nn.functional.silu(x)
def _sigmoid(x):
    return torch.sigmoid(x)
def _layernorm(x, axis=-1, eps=1e-5):
    m = x.mean(dim=axis, keepdim=True)
    v = x.var(dim=axis, keepdim=True, unbiased=False)
    return (x - m) / torch.sqrt(v + eps)
def _scatter_add(tgt, idx, src, axis=0):
    return tgt.clone().index_add_(axis, idx, src)
def _segment_sum(src, seg, n):
    out = torch.zeros((n,) + src.shape[1:], dtype=src.dtype)
    return out.index_add_(0, seg, src)
def _pad(x, pw):
    flat = tuple(v for pair in reversed(pw) for v in pair)
    return torch.nn.functional.pad(x, flat)

kernel_name = 'standalone__gqa_softmax__near_ridge'

def setup_inputs():

    _w = (lambda a: (lambda t: t.to(torch.bfloat16) if t.is_floating_point() else t)(torch.as_tensor(a)))
    B, Hq, Hkv, Sq, Sk, D = 8, 32, 32, 288, 512, 128
    return {
        "q": _w((lambda *s: torch.randn(*s, dtype=torch.bfloat16) * 0.8)(B, Hq, Sq, D)),
        "k": _w((lambda *s: torch.randn(*s, dtype=torch.bfloat16) * 0.8)(B, Hkv, Sk, D)),
        "v": _w((lambda *s: torch.randn(*s, dtype=torch.bfloat16) * 0.05)(B, Hkv, Sk, D)),
    }

def reference(q, k, v):
    B, Hq, Sq, D = q.shape
    Hkv = k.shape[1]
    rep = Hq // Hkv
    k = (lambda x, n, axis: torch.repeat_interleave(x, n, dim=axis))(k, rep, axis=1)
    v = (lambda x, n, axis: torch.repeat_interleave(x, n, dim=axis))(v, rep, axis=1)
    scale = D ** -0.5
    scores = torch.einsum("bhqd,bhkd->bhqk", q, k) * scale
    p = _softmax(scores, axis=-1)
    return torch.einsum("bhqk,bhkd->bhqd", p, v)
```

```asm
; @launch grid=(256,1,1) block=(256,1,1) lds=163840
.amdgcn_target "amdgcn-amd-amdhsa--gfx950"
.text
.globl standalone__gqa_softmax__near_ridge_kernel
.p2align 8
.type standalone__gqa_softmax__near_ridge_kernel,@function
standalone__gqa_softmax__near_ridge_kernel:
    s_cmp_ge_u32 s2, 256
    s_cbranch_scc1 L_end
    s_load_dwordx4 s[4:7], s[0:1], 0
    s_load_dwordx4 s[8:11], s[0:1], 16
    s_getpc_b64 s[56:57]
    v_mul_u32_u24 v177, 68, v0
    global_load_dword v16, v177, s[56:57]
    v_lshrrev_b32 v177, 6, v0
    v_and_b32 v0, 63, v0
    v_readfirstlane_b32 s30, v177
    v_bfe_u32 v177, v0, 2, 2
    v_lshrrev_b32 v178, 4, v0
    v_and_b32 v179, 3, v0
    v_lshlrev_b32 v180, 8, v177
    v_lshl_add_u32 v180, v178, 6, v180
    v_lshl_add_u32 v5, v179, 4, v180
    v_xor_b32 v6, 48, v5
    v_xor_b32 v7, 32, v5
    v_xor_b32 v8, 16, v5
    s_mul_i32 s28, s2, 73728
    s_lshl_b32 s29, s2, 17
    s_lshl_b32 s45, s30, 12
    s_waitcnt lgkmcnt(0)
    s_add_u32 s16, s6, s29
    s_addc_u32 s17, s7, 0
    s_mov_b32 s18, 131072
    s_mov_b32 s19, 0x20000
    s_lshr_b32 s94, s2, 0
    s_and_b32 s94, s94, 7
    s_lshl_b32 s94, s94, 14
    s_add_u32 s94, s94, s45
    s_add_u32 m0, s45, 0
    s_add_u32 s42, s94, 0
    s_and_b32 s42, s42, 0x1ffff
    buffer_load_dwordx4 v5, s[16:19], s42 offen nt lds
    buffer_load_dwordx4 v6, s[16:19], s42 offen offset:1024 nt lds
    buffer_load_dwordx4 v7, s[16:19], s42 offen offset:2048 nt lds
    buffer_load_dwordx4 v8, s[16:19], s42 offen offset:3072 nt lds
    s_add_u32 s12, s4, s28
    s_addc_u32 s13, s5, 0
    s_mov_b32 s14, 73728
    s_mov_b32 s15, 0x20000
    s_add_u32 s20, s8, s29
    s_addc_u32 s21, s9, 0
    s_mov_b32 s22, 131072
    s_mov_b32 s23, 0x20000
    s_add_u32 s24, s10, s28
    s_addc_u32 s25, s11, 0
    s_mov_b32 s26, 73728
    s_mov_b32 s27, 0x20000
    s_lshl_b32 s28, s30, 14
    s_lshr_b32 s49, s30, 1
    s_lshl_b32 s49, s49, 12
    s_add_u32 m0, s45, 81920
    s_add_u32 s95, s28, 0
    buffer_load_dwordx4 v5, s[12:15], s95 offen nt lds
    buffer_load_dwordx4 v6, s[12:15], s95 offen offset:1024 nt lds
    buffer_load_dwordx4 v7, s[12:15], s95 offen offset:2048 nt lds
    buffer_load_dwordx4 v8, s[12:15], s95 offen offset:3072 nt lds
    s_and_b32 s46, s30, 1
    s_lshl_b32 s42, s46, 13
    s_xor_b32 s43, s42, 8192
    v_sub_u32 v180, 0, v178
    v_and_b32 v180, 3, v180
    v_xor_b32 v180, v180, v179
    v_lshlrev_b32 v180, 4, v180
    v_lshl_add_u32 v180, v177, 6, v180
    v_lshl_add_u32 v180, v178, 10, v180
    v_add_u32 v180, 16384, v180
    v_add_u32 v3, s42, v180
    v_add_u32 v4, s43, v180
    v_sub_u32 v180, 0, v177
    v_and_b32 v180, 3, v180
    v_xor_b32 v180, v180, v178
    v_lshlrev_b32 v180, 4, v180
    v_lshl_add_u32 v180, v179, 6, v180
    v_lshl_add_u32 v180, v177, 10, v180
    v_add_u32 v1, s42, v180
    v_add_u32 v2, s43, v180
    s_add_u32 s44, s45, 81920
    v_add_u32 v10, s44, v180
    v_add_u32 v11, 65536, v10
    v_and_b32 v180, 15, v0
    v_lshlrev_b32 v180, 8, v180
    v_lshl_add_u32 v9, v178, 4, v180
    s_mov_b32 s47, 0xffff0000
    s_mov_b32 s48, 0x3e0293ee
    s_mov_b32 s40, 32768
    s_mov_b32 s41, 4294836224
    s_add_u32 s33, s45, 114688
    s_add_u32 s32, s45, 131072
    s_add_u32 s38, s45, 49152
    s_add_u32 s39, s45, 65536
    s_add_u32 s37, s94, 49152
    s_add_u32 s36, s94, 65536
    s_and_b32 s37, s37, 0x1ffff
    s_and_b32 s36, s36, 0x1ffff
    s_mov_b32 s31, 1
    s_mov_b32 s54, 0x3c800000
    s_mov_b32 s55, 0x46000000
    s_mov_b64 s[50:51], 0
    s_mov_b64 s[52:53], 0
    s_add_u32 s96, s28, 0
    s_add_u32 s97, s28, 4096
    s_add_u32 s98, s28, 8192
    s_add_u32 s99, s28, 12288
    s_lshl_b32 s42, s46, 7
    s_add_u32 s100, s49, s42
    s_add_u32 s100, s100, 65536
    v_add_u32 v252, 65536, v1
    v_add_u32 v253, 65536, v2
    v_mov_b32 v254, 0x3f803f80
    v_accvgpr_write_b32 a232, v254
    v_accvgpr_write_b32 a233, v254
    v_accvgpr_write_b32 a234, v254
    v_accvgpr_write_b32 a235, v254
    v_and_b32 v255, 1, v0
    v_add_u32 v255, -1, v255
    v_and_b32 v254, v255, v254
    v_and_b32 v255, 0xaaaaaaaa, v255
    v_xor_b32 v14, 0xeeeeeeee, v255
    v_accvgpr_write_b32 a164, v254
    v_accvgpr_write_b32 a165, v254
    v_accvgpr_write_b32 a166, v254
    v_accvgpr_write_b32 a167, v254
    s_waitcnt vmcnt(4)
    s_add_u32 m0, s45, 98304
    s_add_u32 s95, s28, 4096
    buffer_load_dwordx4 v5, s[12:15], s95 offen nt lds
    buffer_load_dwordx4 v6, s[12:15], s95 offen offset:1024 nt lds
    buffer_load_dwordx4 v7, s[12:15], s95 offen offset:2048 nt lds
    buffer_load_dwordx4 v8, s[12:15], s95 offen offset:3072 nt lds
    s_waitcnt vmcnt(8)
    s_barrier
    ds_read_b128 a[80:83], v1 offset:0
    ds_read_b128 a[84:87], v1 offset:256
    ds_read_b128 a[88:91], v1 offset:512
    ds_read_b128 a[92:95], v1 offset:768
    ds_read_b128 a[96:99], v1 offset:4096
    ds_read_b128 a[100:103], v1 offset:4352
    s_waitcnt vmcnt(4)
    ds_read_b128 v[16:19], v10 offset:0
    ds_read_b128 v[20:23], v10 offset:256
    ds_read_b128 v[24:27], v10 offset:512
    ds_read_b128 v[28:31], v10 offset:768
    s_waitcnt lgkmcnt(3)
    v_lshlrev_b32 v32, 16, v16
    v_and_b32 v33, s47, v16
    v_lshlrev_b32 v34, 16, v17
    v_and_b32 v35, s47, v17
    v_mul_f32 v32, s48, v32
    v_mul_f32 v33, s48, v33
    v_mul_f32 v34, s48, v34
    v_mul_f32 v35, s48, v35
    v_cvt_pk_bf16_f32 v16, v32, v33
    v_cvt_pk_bf16_f32 v17, v34, v35
    v_accvgpr_write_b32 a0, v16
    v_accvgpr_write_b32 a1, v17
    v_lshlrev_b32 v36, 16, v18
    v_and_b32 v37, s47, v18
    v_lshlrev_b32 v38, 16, v19
    v_and_b32 v39, s47, v19
    v_mul_f32 v36, s48, v36
    v_mul_f32 v37, s48, v37
    v_mul_f32 v38, s48, v38
    v_mul_f32 v39, s48, v39
    v_cvt_pk_bf16_f32 v18, v36, v37
    v_cvt_pk_bf16_f32 v19, v38, v39
    v_accvgpr_write_b32 a2, v18
    v_accvgpr_write_b32 a3, v19
    s_add_u32 m0, s45, 114688
    s_add_u32 s95, s28, 8192
    buffer_load_dwordx4 v5, s[12:15], s95 offen nt lds
    buffer_load_dwordx4 v6, s[12:15], s95 offen offset:1024 nt lds
    buffer_load_dwordx4 v7, s[12:15], s95 offen offset:2048 nt lds
    buffer_load_dwordx4 v8, s[12:15], s95 offen offset:3072 nt lds
    ds_read_b128 a[104:107], v1 offset:4608
    v_mfma_f32_16x16x32_bf16 v[176:179], a[80:83], a[0:3], -4.0
    s_waitcnt lgkmcnt(3)
    v_lshlrev_b32 v40, 16, v20
    v_and_b32 v41, s47, v20
    v_lshlrev_b32 v42, 16, v21
    v_and_b32 v43, s47, v21
    v_mul_f32 v40, s48, v40
    v_mul_f32 v41, s48, v41
    v_mul_f32 v42, s48, v42
    v_mul_f32 v43, s48, v43
    v_cvt_pk_bf16_f32 v20, v40, v41
    v_cvt_pk_bf16_f32 v21, v42, v43
    v_accvgpr_write_b32 a4, v20
    v_accvgpr_write_b32 a5, v21
    v_lshlrev_b32 v44, 16, v22
    v_and_b32 v45, s47, v22
    v_lshlrev_b32 v46, 16, v23
    v_and_b32 v47, s47, v23
    v_mul_f32 v44, s48, v44
    v_mul_f32 v45, s48, v45
    v_mul_f32 v46, s48, v46
    v_mul_f32 v47, s48, v47
    v_cvt_pk_bf16_f32 v22, v44, v45
    v_cvt_pk_bf16_f32 v23, v46, v47
    v_accvgpr_write_b32 a6, v22
    v_accvgpr_write_b32 a7, v23
    ds_read_b128 a[108:111], v1 offset:4864
    s_nop 0
    v_mfma_f32_16x16x32_bf16 v[176:179], a[84:87], a[4:7], v[176:179]
    s_waitcnt lgkmcnt(3)
    v_lshlrev_b32 v32, 16, v24
    v_and_b32 v33, s47, v24
    v_lshlrev_b32 v34, 16, v25
    v_and_b32 v35, s47, v25
    v_mul_f32 v32, s48, v32
    v_mul_f32 v33, s48, v33
    v_mul_f32 v34, s48, v34
    v_mul_f32 v35, s48, v35
    v_cvt_pk_bf16_f32 v24, v32, v33
    v_cvt_pk_bf16_f32 v25, v34, v35
    v_accvgpr_write_b32 a8, v24
    v_accvgpr_write_b32 a9, v25
    v_lshlrev_b32 v36, 16, v26
    v_and_b32 v37, s47, v26
    v_lshlrev_b32 v38, 16, v27
    v_and_b32 v39, s47, v27
    v_mul_f32 v36, s48, v36
    v_mul_f32 v37, s48, v37
    v_mul_f32 v38, s48, v38
    v_mul_f32 v39, s48, v39
    v_cvt_pk_bf16_f32 v26, v36, v37
    v_cvt_pk_bf16_f32 v27, v38, v39
    v_accvgpr_write_b32 a10, v26
    v_accvgpr_write_b32 a11, v27
    ds_read_b128 a[200:203], v2 offset:0
    s_nop 0
    v_mfma_f32_16x16x32_bf16 v[176:179], a[88:91], a[8:11], v[176:179]
    s_waitcnt lgkmcnt(3)
    v_lshlrev_b32 v40, 16, v28
    v_and_b32 v41, s47, v28
    v_lshlrev_b32 v42, 16, v29
    v_and_b32 v43, s47, v29
    v_mul_f32 v40, s48, v40
    v_mul_f32 v41, s48, v41
    v_mul_f32 v42, s48, v42
    v_mul_f32 v43, s48, v43
    v_cvt_pk_bf16_f32 v28, v40, v41
    v_cvt_pk_bf16_f32 v29, v42, v43
    v_accvgpr_write_b32 a12, v28
    v_accvgpr_write_b32 a13, v29
    v_lshlrev_b32 v44, 16, v30
    v_and_b32 v45, s47, v30
    v_lshlrev_b32 v46, 16, v31
    v_and_b32 v47, s47, v31
    v_mul_f32 v44, s48, v44
    v_mul_f32 v45, s48, v45
    v_mul_f32 v46, s48, v46
    v_mul_f32 v47, s48, v47
    v_cvt_pk_bf16_f32 v30, v44, v45
    v_cvt_pk_bf16_f32 v31, v46, v47
    v_accvgpr_write_b32 a14, v30
    v_accvgpr_write_b32 a15, v31
    ds_read_b128 a[204:207], v2 offset:256
    s_nop 0
    v_mfma_f32_16x16x32_bf16 v[176:179], a[92:95], a[12:15], v[176:179]
    ds_read_b128 a[208:211], v2 offset:512
    ds_read_b128 a[212:215], v2 offset:768
    ds_read_b128 a[216:219], v2 offset:4096
    ds_read_b128 a[220:223], v2 offset:4352
    ds_read_b128 a[224:227], v2 offset:4608
    v_mfma_f32_16x16x32_bf16 v[180:183], a[96:99], a[0:3], -4.0
    ds_read_b128 a[228:231], v2 offset:4864
    v_mfma_f32_16x16x32_bf16 v[180:183], a[100:103], a[4:7], v[180:183]
    v_exp_f32 v176, v176
    v_exp_f32 v177, v177
    v_exp_f32 v178, v178
    s_waitcnt lgkmcnt(9)
    v_mfma_f32_16x16x32_bf16 v[180:183], a[104:107], a[8:11], v[180:183]
    v_exp_f32 v179, v179
    v_cvt_pk_bf16_f32 v216, v176, v177
    v_cvt_pk_bf16_f32 v217, v178, v179
    s_waitcnt lgkmcnt(8)
    v_mfma_f32_16x16x32_bf16 v[180:183], a[108:111], a[12:15], v[180:183]
    s_waitcnt lgkmcnt(7)
    v_mfma_f32_16x16x32_bf16 v[184:187], a[200:203], a[0:3], -4.0
    s_waitcnt lgkmcnt(6)
    v_mfma_f32_16x16x32_bf16 v[184:187], a[204:207], a[4:7], v[184:187]
    v_exp_f32 v180, v180
    v_exp_f32 v181, v181
    v_exp_f32 v182, v182
    s_waitcnt lgkmcnt(5)
    v_mfma_f32_16x16x32_bf16 v[184:187], a[208:211], a[8:11], v[184:187]
    v_exp_f32 v183, v183
    v_cvt_pk_bf16_f32 v218, v180, v181
    v_cvt_pk_bf16_f32 v219, v182, v183
    s_waitcnt lgkmcnt(4)
    v_mfma_f32_16x16x32_bf16 v[184:187], a[212:215], a[12:15], v[184:187]
    s_waitcnt lgkmcnt(3)
    v_mfma_f32_16x16x32_bf16 v[188:191], a[216:219], a[0:3], -4.0
    s_waitcnt lgkmcnt(2)
    v_mfma_f32_16x16x32_bf16 v[188:191], a[220:223], a[4:7], v[188:191]
    v_exp_f32 v184, v184
    v_exp_f32 v185, v185
    v_exp_f32 v186, v186
    s_waitcnt lgkmcnt(1)
    v_mfma_f32_16x16x32_bf16 v[188:191], a[224:227], a[8:11], v[188:191]
    v_exp_f32 v187, v187
    v_cvt_pk_bf16_f32 v220, v184, v185
    v_cvt_pk_bf16_f32 v221, v186, v187
    s_waitcnt lgkmcnt(0)
    v_mfma_f32_16x16x32_bf16 v[188:191], a[228:231], a[12:15], v[188:191]
    s_nop 7
    v_exp_f32 v188, v188
    v_exp_f32 v189, v189
    v_exp_f32 v190, v190
    v_exp_f32 v191, v191
    v_cvt_pk_bf16_f32 v222, v188, v189
    v_cvt_pk_bf16_f32 v223, v190, v191
    s_waitcnt vmcnt(4)
    ds_read_b128 v[48:51], v10 offset:16384
    ds_read_b128 v[52:55], v10 offset:16640
    ds_read_b128 v[56:59], v10 offset:16896
    ds_read_b128 v[60:63], v10 offset:17152
    s_waitcnt lgkmcnt(3)
    v_lshlrev_b32 v64, 16, v48
    v_and_b32 v65, s47, v48
    v_lshlrev_b32 v66, 16, v49
    v_and_b32 v67, s47, v49
    v_mul_f32 v64, s48, v64
    v_mul_f32 v65, s48, v65
    v_mul_f32 v66, s48, v66
    v_mul_f32 v67, s48, v67
    v_cvt_pk_bf16_f32 v48, v64, v65
    v_cvt_pk_bf16_f32 v49, v66, v67
    v_accvgpr_write_b32 a16, v48
    v_accvgpr_write_b32 a17, v49
    v_lshlrev_b32 v68, 16, v50
    v_and_b32 v69, s47, v50
    v_lshlrev_b32 v70, 16, v51
    v_and_b32 v71, s47, v51
    v_mul_f32 v68, s48, v68
    v_mul_f32 v69, s48, v69
    v_mul_f32 v70, s48, v70
    v_mul_f32 v71, s48, v71
    v_cvt_pk_bf16_f32 v50, v68, v69
    v_cvt_pk_bf16_f32 v51, v70, v71
    v_accvgpr_write_b32 a18, v50
    v_accvgpr_write_b32 a19, v51
    s_add_u32 m0, s45, 131072
    s_add_u32 s95, s28, 12288
    buffer_load_dwordx4 v5, s[12:15], s95 offen nt lds
    buffer_load_dwordx4 v6, s[12:15], s95 offen offset:1024 nt lds
    buffer_load_dwordx4 v7, s[12:15], s95 offen offset:2048 nt lds
    buffer_load_dwordx4 v8, s[12:15], s95 offen offset:3072 nt lds
    v_mfma_f32_16x16x32_bf16 v[192:195], a[80:83], a[16:19], -4.0
    s_waitcnt lgkmcnt(2)
    v_lshlrev_b32 v72, 16, v52
    v_and_b32 v73, s47, v52
    v_lshlrev_b32 v74, 16, v53
    v_and_b32 v75, s47, v53
    v_mul_f32 v72, s48, v72
    v_mul_f32 v73, s48, v73
    v_mul_f32 v74, s48, v74
    v_mul_f32 v75, s48, v75
    v_cvt_pk_bf16_f32 v52, v72, v73
    v_cvt_pk_bf16_f32 v53, v74, v75
    v_accvgpr_write_b32 a20, v52
    v_accvgpr_write_b32 a21, v53
    v_lshlrev_b32 v76, 16, v54
    v_and_b32 v77, s47, v54
    v_lshlrev_b32 v78, 16, v55
    v_and_b32 v79, s47, v55
    v_mul_f32 v76, s48, v76
    v_mul_f32 v77, s48, v77
    v_mul_f32 v78, s48, v78
    v_mul_f32 v79, s48, v79
    v_cvt_pk_bf16_f32 v54, v76, v77
    v_cvt_pk_bf16_f32 v55, v78, v79
    v_accvgpr_write_b32 a22, v54
    v_accvgpr_write_b32 a23, v55
    s_nop 1
    v_mfma_f32_16x16x32_bf16 v[192:195], a[84:87], a[20:23], v[192:195]
    s_waitcnt lgkmcnt(1)
    v_lshlrev_b32 v64, 16, v56
    v_and_b32 v65, s47, v56
    v_lshlrev_b32 v66, 16, v57
    v_and_b32 v67, s47, v57
    v_mul_f32 v64, s48, v64
    v_mul_f32 v65, s48, v65
    v_mul_f32 v66, s48, v66
    v_mul_f32 v67, s48, v67
    v_cvt_pk_bf16_f32 v56, v64, v65
    v_cvt_pk_bf16_f32 v57, v66, v67
    v_accvgpr_write_b32 a24, v56
    v_accvgpr_write_b32 a25, v57
    v_lshlrev_b32 v68, 16, v58
    v_and_b32 v69, s47, v58
    v_lshlrev_b32 v70, 16, v59
    v_and_b32 v71, s47, v59
    v_mul_f32 v68, s48, v68
    v_mul_f32 v69, s48, v69
    v_mul_f32 v70, s48, v70
    v_mul_f32 v71, s48, v71
    v_cvt_pk_bf16_f32 v58, v68, v69
    v_cvt_pk_bf16_f32 v59, v70, v71
    v_accvgpr_write_b32 a26, v58
    v_accvgpr_write_b32 a27, v59
    s_nop 1
    v_mfma_f32_16x16x32_bf16 v[192:195], a[88:91], a[24:27], v[192:195]
    s_waitcnt lgkmcnt(0)
    v_lshlrev_b32 v72, 16, v60
    v_and_b32 v73, s47, v60
    v_lshlrev_b32 v74, 16, v61
    v_and_b32 v75, s47, v61
    v_mul_f32 v72, s48, v72
    v_mul_f32 v73, s48, v73
    v_mul_f32 v74, s48, v74
    v_mul_f32 v75, s48, v75
    v_cvt_pk_bf16_f32 v60, v72, v73
    v_cvt_pk_bf16_f32 v61, v74, v75
    v_accvgpr_write_b32 a28, v60
    v_accvgpr_write_b32 a29, v61
    v_lshlrev_b32 v76, 16, v62
    v_and_b32 v77, s47, v62
    v_lshlrev_b32 v78, 16, v63
    v_and_b32 v79, s47, v63
    v_mul_f32 v76, s48, v76
    v_mul_f32 v77, s48, v77
    v_mul_f32 v78, s48, v78
    v_mul_f32 v79, s48, v79
    v_cvt_pk_bf16_f32 v62, v76, v77
    v_cvt_pk_bf16_f32 v63, v78, v79
    v_accvgpr_write_b32 a30, v62
    v_accvgpr_write_b32 a31, v63
    s_nop 1
    v_mfma_f32_16x16x32_bf16 v[192:195], a[92:95], a[28:31], v[192:195]
    v_mfma_f32_16x16x32_bf16 v[196:199], a[96:99], a[16:19], -4.0
    v_mfma_f32_16x16x32_bf16 v[196:199], a[100:103], a[20:23], v[196:199]
    v_exp_f32 v192, v192
    v_exp_f32 v193, v193
    v_exp_f32 v194, v194
    v_mfma_f32_16x16x32_bf16 v[196:199], a[104:107], a[24:27], v[196:199]
    v_exp_f32 v195, v195
    v_cvt_pk_bf16_f32 v224, v192, v193
    v_cvt_pk_bf16_f32 v225, v194, v195
    v_mfma_f32_16x16x32_bf16 v[196:199], a[108:111], a[28:31], v[196:199]
    v_mfma_f32_16x16x32_bf16 v[200:203], a[200:203], a[16:19], -4.0
    v_mfma_f32_16x16x32_bf16 v[200:203], a[204:207], a[20:23], v[200:203]
    v_exp_f32 v196, v196
    v_exp_f32 v197, v197
    v_exp_f32 v198, v198
    v_mfma_f32_16x16x32_bf16 v[200:203], a[208:211], a[24:27], v[200:203]
    v_exp_f32 v199, v199
    v_cvt_pk_bf16_f32 v226, v196, v197
    v_cvt_pk_bf16_f32 v227, v198, v199
    v_mfma_f32_16x16x32_bf16 v[200:203], a[212:215], a[28:31], v[200:203]
    v_mfma_f32_16x16x32_bf16 v[204:207], a[216:219], a[16:19], -4.0
    v_mfma_f32_16x16x32_bf16 v[204:207], a[220:223], a[20:23], v[204:207]
    v_exp_f32 v200, v200
    v_exp_f32 v201, v201
    v_exp_f32 v202, v202
    v_mfma_f32_16x16x32_bf16 v[204:207], a[224:227], a[24:27], v[204:207]
    v_exp_f32 v203, v203
    v_cvt_pk_bf16_f32 v228, v200, v201
    v_cvt_pk_bf16_f32 v229, v202, v203
    v_mfma_f32_16x16x32_bf16 v[204:207], a[228:231], a[28:31], v[204:207]
    s_nop 7
    v_exp_f32 v204, v204
    v_exp_f32 v205, v205
    v_exp_f32 v206, v206
    v_exp_f32 v207, v207
    v_cvt_pk_bf16_f32 v230, v204, v205
    v_cvt_pk_bf16_f32 v231, v206, v207
    s_waitcnt vmcnt(4)
    ds_read_b128 v[80:83], v10 offset:32768
    ds_read_b128 v[84:87], v10 offset:33024
    ds_read_b128 v[88:91], v10 offset:33280
    ds_read_b128 v[92:95], v10 offset:33536
    s_waitcnt lgkmcnt(3)
    v_lshlrev_b32 v96, 16, v80
    v_and_b32 v97, s47, v80
    v_lshlrev_b32 v98, 16, v81
    v_and_b32 v99, s47, v81
    v_mul_f32 v96, s48, v96
    v_mul_f32 v97, s48, v97
    v_mul_f32 v98, s48, v98
    v_mul_f32 v99, s48, v99
    v_cvt_pk_bf16_f32 v80, v96, v97
    v_cvt_pk_bf16_f32 v81, v98, v99
    v_accvgpr_write_b32 a32, v80
    v_accvgpr_write_b32 a33, v81
    v_lshlrev_b32 v100, 16, v82
    v_and_b32 v101, s47, v82
    v_lshlrev_b32 v102, 16, v83
    v_and_b32 v103, s47, v83
    v_mul_f32 v100, s48, v100
    v_mul_f32 v101, s48, v101
    v_mul_f32 v102, s48, v102
    v_mul_f32 v103, s48, v103
    v_cvt_pk_bf16_f32 v82, v100, v101
    v_cvt_pk_bf16_f32 v83, v102, v103
    v_accvgpr_write_b32 a34, v82
    v_accvgpr_write_b32 a35, v83
    s_add_u32 m0, s45, 16384
    s_add_u32 s95, s94, 0
    s_and_b32 s95, s95, 0x1ffff
    buffer_load_dwordx4 v5, s[20:23], s95 offen nt lds
    buffer_load_dwordx4 v6, s[20:23], s95 offen offset:1024 nt lds
    buffer_load_dwordx4 v7, s[20:23], s95 offen offset:2048 nt lds
    buffer_load_dwordx4 v8, s[20:23], s95 offen offset:3072 nt lds
    v_mfma_f32_16x16x32_bf16 v[208:211], a[80:83], a[32:35], -4.0
    s_waitcnt lgkmcnt(2)
    v_lshlrev_b32 v104, 16, v84
    v_and_b32 v105, s47, v84
    v_lshlrev_b32 v106, 16, v85
    v_and_b32 v107, s47, v85
    v_mul_f32 v104, s48, v104
    v_mul_f32 v105, s48, v105
    v_mul_f32 v106, s48, v106
    v_mul_f32 v107, s48, v107
    v_cvt_pk_bf16_f32 v84, v104, v105
    v_cvt_pk_bf16_f32 v85, v106, v107
    v_accvgpr_write_b32 a36, v84
    v_accvgpr_write_b32 a37, v85
    v_lshlrev_b32 v108, 16, v86
    v_and_b32 v109, s47, v86
    v_lshlrev_b32 v110, 16, v87
    v_and_b32 v111, s47, v87
    v_mul_f32 v108, s48, v108
    v_mul_f32 v109, s48, v109
    v_mul_f32 v110, s48, v110
    v_mul_f32 v111, s48, v111
    v_cvt_pk_bf16_f32 v86, v108, v109
    v_cvt_pk_bf16_f32 v87, v110, v111
    v_accvgpr_write_b32 a38, v86
    v_accvgpr_write_b32 a39, v87
    s_nop 1
    v_mfma_f32_16x16x32_bf16 v[208:211], a[84:87], a[36:39], v[208:211]
    s_waitcnt lgkmcnt(1)
    v_lshlrev_b32 v96, 16, v88
    v_and_b32 v97, s47, v88
    v_lshlrev_b32 v98, 16, v89
    v_and_b32 v99, s47, v89
    v_mul_f32 v96, s48, v96
    v_mul_f32 v97, s48, v97
    v_mul_f32 v98, s48, v98
    v_mul_f32 v99, s48, v99
    v_cvt_pk_bf16_f32 v88, v96, v97
    v_cvt_pk_bf16_f32 v89, v98, v99
    v_accvgpr_write_b32 a40, v88
    v_accvgpr_write_b32 a41, v89
    v_lshlrev_b32 v100, 16, v90
    v_and_b32 v101, s47, v90
    v_lshlrev_b32 v102, 16, v91
    v_and_b32 v103, s47, v91
    v_mul_f32 v100, s48, v100
    v_mul_f32 v101, s48, v101
    v_mul_f32 v102, s48, v102
    v_mul_f32 v103, s48, v103
    v_cvt_pk_bf16_f32 v90, v100, v101
    v_cvt_pk_bf16_f32 v91, v102, v103
    v_accvgpr_write_b32 a42, v90
    v_accvgpr_write_b32 a43, v91
    s_nop 1
    v_mfma_f32_16x16x32_bf16 v[208:211], a[88:91], a[40:43], v[208:211]
    s_waitcnt lgkmcnt(0)
    v_lshlrev_b32 v104, 16, v92
    v_and_b32 v105, s47, v92
    v_lshlrev_b32 v106, 16, v93
    v_and_b32 v107, s47, v93
    v_mul_f32 v104, s48, v104
    v_mul_f32 v105, s48, v105
    v_mul_f32 v106, s48, v106
    v_mul_f32 v107, s48, v107
    v_cvt_pk_bf16_f32 v92, v104, v105
    v_cvt_pk_bf16_f32 v93, v106, v107
    v_accvgpr_write_b32 a44, v92
    v_accvgpr_write_b32 a45, v93
    v_lshlrev_b32 v108, 16, v94
    v_and_b32 v109, s47, v94
    v_lshlrev_b32 v110, 16, v95
    v_and_b32 v111, s47, v95
    v_mul_f32 v108, s48, v108
    v_mul_f32 v109, s48, v109
    v_mul_f32 v110, s48, v110
    v_mul_f32 v111, s48, v111
    v_cvt_pk_bf16_f32 v94, v108, v109
    v_cvt_pk_bf16_f32 v95, v110, v111
    v_accvgpr_write_b32 a46, v94
    v_accvgpr_write_b32 a47, v95
    s_nop 1
    v_mfma_f32_16x16x32_bf16 v[208:211], a[92:95], a[44:47], v[208:211]
    v_mfma_f32_16x16x32_bf16 v[212:215], a[96:99], a[32:35], -4.0
    v_mfma_f32_16x16x32_bf16 v[212:215], a[100:103], a[36:39], v[212:215]
    v_exp_f32 v208, v208
    v_exp_f32 v209, v209
    v_exp_f32 v210, v210
    v_mfma_f32_16x16x32_bf16 v[212:215], a[104:107], a[40:43], v[212:215]
    v_exp_f32 v211, v211
    v_cvt_pk_bf16_f32 v232, v208, v209
    v_cvt_pk_bf16_f32 v233, v210, v211
    v_mfma_f32_16x16x32_bf16 v[212:215], a[108:111], a[44:47], v[212:215]
    v_mfma_f32_16x16x32_bf16 v[176:179], a[200:203], a[32:35], -4.0
    v_mfma_f32_16x16x32_bf16 v[176:179], a[204:207], a[36:39], v[176:179]
    v_exp_f32 v212, v212
    v_exp_f32 v213, v213
    v_exp_f32 v214, v214
    v_mfma_f32_16x16x32_bf16 v[176:179], a[208:211], a[40:43], v[176:179]
    v_exp_f32 v215, v215
    v_cvt_pk_bf16_f32 v234, v212, v213
    v_cvt_pk_bf16_f32 v235, v214, v215
    v_mfma_f32_16x16x32_bf16 v[176:179], a[212:215], a[44:47], v[176:179]
    v_mfma_f32_16x16x32_bf16 v[180:183], a[216:219], a[32:35], -4.0
    v_mfma_f32_16x16x32_bf16 v[180:183], a[220:223], a[36:39], v[180:183]
    v_exp_f32 v176, v176
    v_exp_f32 v177, v177
    v_exp_f32 v178, v178
    v_mfma_f32_16x16x32_bf16 v[180:183], a[224:227], a[40:43], v[180:183]
    v_exp_f32 v179, v179
    v_cvt_pk_bf16_f32 v236, v176, v177
    v_cvt_pk_bf16_f32 v237, v178, v179
    v_mfma_f32_16x16x32_bf16 v[180:183], a[228:231], a[44:47], v[180:183]
    s_nop 7
    v_exp_f32 v180, v180
    v_exp_f32 v181, v181
    v_exp_f32 v182, v182
    v_exp_f32 v183, v183
    v_cvt_pk_bf16_f32 v238, v180, v181
    v_cvt_pk_bf16_f32 v239, v182, v183
    s_waitcnt vmcnt(4)
    ds_read_b128 v[112:115], v10 offset:49152
    ds_read_b128 v[116:119], v10 offset:49408
    ds_read_b128 v[120:123], v10 offset:49664
    ds_read_b128 v[124:127], v10 offset:49920
    s_waitcnt lgkmcnt(3)
    v_lshlrev_b32 v128, 16, v112
    v_and_b32 v129, s47, v112
    v_lshlrev_b32 v130, 16, v113
    v_and_b32 v131, s47, v113
    v_mul_f32 v128, s48, v128
    v_mul_f32 v129, s48, v129
    v_mul_f32 v130, s48, v130
    v_mul_f32 v131, s48, v131
    v_cvt_pk_bf16_f32 v112, v128, v129
    v_cvt_pk_bf16_f32 v113, v130, v131
    v_accvgpr_write_b32 a48, v112
    v_accvgpr_write_b32 a49, v113
    v_lshlrev_b32 v132, 16, v114
    v_and_b32 v133, s47, v114
    v_lshlrev_b32 v134, 16, v115
    v_and_b32 v135, s47, v115
    v_mul_f32 v132, s48, v132
    v_mul_f32 v133, s48, v133
    v_mul_f32 v134, s48, v134
    v_mul_f32 v135, s48, v135
    v_cvt_pk_bf16_f32 v114, v132, v133
    v_cvt_pk_bf16_f32 v115, v134, v135
    v_accvgpr_write_b32 a50, v114
    v_accvgpr_write_b32 a51, v115
    s_add_u32 m0, s45, 147456
    s_add_u32 s95, s49, 65536
    buffer_load_dwordx4 v5, s[12:15], s95 offen nt lds
    buffer_load_dwordx4 v6, s[12:15], s95 offen offset:1024 nt lds
    buffer_load_dwordx4 v7, s[12:15], s95 offen offset:2048 nt lds
    buffer_load_dwordx4 v8, s[12:15], s95 offen offset:3072 nt lds
    v_mfma_f32_16x16x32_bf16 v[184:187], a[80:83], a[48:51], -4.0
    s_waitcnt lgkmcnt(2)
    v_lshlrev_b32 v136, 16, v116
    v_and_b32 v137, s47, v116
    v_lshlrev_b32 v138, 16, v117
    v_and_b32 v139, s47, v117
    v_mul_f32 v136, s48, v136
    v_mul_f32 v137, s48, v137
    v_mul_f32 v138, s48, v138
    v_mul_f32 v139, s48, v139
    v_cvt_pk_bf16_f32 v116, v136, v137
    v_cvt_pk_bf16_f32 v117, v138, v139
    v_accvgpr_write_b32 a52, v116
    v_accvgpr_write_b32 a53, v117
    v_lshlrev_b32 v140, 16, v118
    v_and_b32 v141, s47, v118
    v_lshlrev_b32 v142, 16, v119
    v_and_b32 v143, s47, v119
    v_mul_f32 v140, s48, v140
    v_mul_f32 v141, s48, v141
    v_mul_f32 v142, s48, v142
    v_mul_f32 v143, s48, v143
    v_cvt_pk_bf16_f32 v118, v140, v141
    v_cvt_pk_bf16_f32 v119, v142, v143
    v_accvgpr_write_b32 a54, v118
    v_accvgpr_write_b32 a55, v119
    s_nop 1
    v_mfma_f32_16x16x32_bf16 v[184:187], a[84:87], a[52:55], v[184:187]
    s_waitcnt lgkmcnt(1)
    v_lshlrev_b32 v128, 16, v120
    v_and_b32 v129, s47, v120
    v_lshlrev_b32 v130, 16, v121
    v_and_b32 v131, s47, v121
    v_mul_f32 v128, s48, v128
    v_mul_f32 v129, s48, v129
    v_mul_f32 v130, s48, v130
    v_mul_f32 v131, s48, v131
    v_cvt_pk_bf16_f32 v120, v128, v129
    v_cvt_pk_bf16_f32 v121, v130, v131
    v_accvgpr_write_b32 a56, v120
    v_accvgpr_write_b32 a57, v121
    v_lshlrev_b32 v132, 16, v122
    v_and_b32 v133, s47, v122
    v_lshlrev_b32 v134, 16, v123
    v_and_b32 v135, s47, v123
    v_mul_f32 v132, s48, v132
    v_mul_f32 v133, s48, v133
    v_mul_f32 v134, s48, v134
    v_mul_f32 v135, s48, v135
    v_cvt_pk_bf16_f32 v122, v132, v133
    v_cvt_pk_bf16_f32 v123, v134, v135
    v_accvgpr_write_b32 a58, v122
    v_accvgpr_write_b32 a59, v123
    s_nop 1
    v_mfma_f32_16x16x32_bf16 v[184:187], a[88:91], a[56:59], v[184:187]
    s_waitcnt lgkmcnt(0)
    v_lshlrev_b32 v136, 16, v124
    v_and_b32 v137, s47, v124
    v_lshlrev_b32 v138, 16, v125
    v_and_b32 v139, s47, v125
    v_mul_f32 v136, s48, v136
    v_mul_f32 v137, s48, v137
    v_mul_f32 v138, s48, v138
    v_mul_f32 v139, s48, v139
    v_cvt_pk_bf16_f32 v124, v136, v137
    v_cvt_pk_bf16_f32 v125, v138, v139
    v_accvgpr_write_b32 a60, v124
    v_accvgpr_write_b32 a61, v125
    v_lshlrev_b32 v140, 16, v126
    v_and_b32 v141, s47, v126
    v_lshlrev_b32 v142, 16, v127
    v_and_b32 v143, s47, v127
    v_mul_f32 v140, s48, v140
    v_mul_f32 v141, s48, v141
    v_mul_f32 v142, s48, v142
    v_mul_f32 v143, s48, v143
    v_cvt_pk_bf16_f32 v126, v140, v141
    v_cvt_pk_bf16_f32 v127, v142, v143
    v_accvgpr_write_b32 a62, v126
    v_accvgpr_write_b32 a63, v127
    s_nop 1
    v_mfma_f32_16x16x32_bf16 v[184:187], a[92:95], a[60:63], v[184:187]
    v_mfma_f32_16x16x32_bf16 v[188:191], a[96:99], a[48:51], -4.0
    v_mfma_f32_16x16x32_bf16 v[188:191], a[100:103], a[52:55], v[188:191]
    v_exp_f32 v184, v184
    v_mfma_f32_16x16x32_bf16 v[188:191], a[104:107], a[56:59], v[188:191]
    v_exp_f32 v185, v185
    v_mfma_f32_16x16x32_bf16 v[188:191], a[108:111], a[60:63], v[188:191]
    v_exp_f32 v186, v186
    v_mfma_f32_16x16x32_bf16 v[192:195], a[200:203], a[48:51], -4.0
    v_exp_f32 v187, v187
    v_cvt_pk_bf16_f32 v240, v184, v185
    v_mfma_f32_16x16x32_bf16 v[192:195], a[204:207], a[52:55], v[192:195]
    v_exp_f32 v188, v188
    v_mfma_f32_16x16x32_bf16 v[192:195], a[208:211], a[56:59], v[192:195]
    v_exp_f32 v189, v189
    v_mfma_f32_16x16x32_bf16 v[192:195], a[212:215], a[60:63], v[192:195]
    v_exp_f32 v190, v190
    v_mfma_f32_16x16x32_bf16 v[196:199], a[216:219], a[48:51], -4.0
    v_exp_f32 v191, v191
    v_mfma_f32_16x16x32_bf16 v[196:199], a[220:223], a[52:55], v[196:199]
    v_cvt_pk_bf16_f32 v242, v188, v189
    v_cvt_pk_bf16_f32 v241, v186, v187
    v_mfma_f32_16x16x32_bf16 v[196:199], a[224:227], a[56:59], v[196:199]
    v_cvt_pk_bf16_f32 v243, v190, v191
    v_mfma_f32_16x16x32_bf16 v[196:199], a[228:231], a[60:63], v[196:199]
    v_exp_f32 v192, v192
    v_exp_f32 v193, v193
    v_exp_f32 v194, v194
    v_exp_f32 v195, v195
    v_cvt_pk_bf16_f32 v244, v192, v193
    v_cvt_pk_bf16_f32 v245, v194, v195
    s_nop 1
    v_exp_f32 v196, v196
    v_exp_f32 v197, v197
    v_exp_f32 v198, v198
    v_exp_f32 v199, v199
    v_cvt_pk_bf16_f32 v246, v196, v197
    v_cvt_pk_bf16_f32 v247, v198, v199
    s_waitcnt vmcnt(4)
    s_add_u32 m0, s45, 32768
    s_add_u32 s95, s94, 16384
    s_and_b32 s95, s95, 0x1ffff
    buffer_load_dwordx4 v5, s[16:19], s95 offen nt lds
    buffer_load_dwordx4 v6, s[16:19], s95 offen offset:1024 nt lds
    buffer_load_dwordx4 v7, s[16:19], s95 offen offset:2048 nt lds
    buffer_load_dwordx4 v8, s[16:19], s95 offen offset:3072 nt lds
    s_waitcnt vmcnt(8)
    s_barrier
    ds_read_b64_tr_b16 a[112:113], v3 offset:0
    ds_read_b64_tr_b16 a[114:115], v3 offset:4096
    v_mfma_f32_16x16x32_bf16 a[144:147], a[164:167], v[216:219], 0
    ds_read_b64_tr_b16 a[116:117], v3 offset:8
    ds_read_b64_tr_b16 a[118:119], v3 offset:4104
    v_mfma_f32_16x16x32_bf16 a[148:151], a[164:167], v[224:227], 0
    ds_read_b64_tr_b16 a[120:121], v3 offset:256
    ds_read_b64_tr_b16 a[122:123], v3 offset:4352
    v_mfma_f32_16x16x32_bf16 a[152:155], a[164:167], v[232:235], 0
    ds_read_b64_tr_b16 a[124:125], v3 offset:264
    ds_read_b64_tr_b16 a[126:127], v3 offset:4360
    v_mfma_f32_16x16x32_bf16 a[156:159], a[164:167], v[240:243], 0
    ds_read_b64_tr_b16 a[128:129], v3 offset:512
    ds_read_b64_tr_b16 a[130:131], v3 offset:4608
    s_waitcnt lgkmcnt(8)
    v_mfma_f32_16x16x32_bf16 v[16:19], a[112:115], v[216:219], 0
    ds_read_b64_tr_b16 a[132:133], v3 offset:520
    ds_read_b64_tr_b16 a[134:135], v3 offset:4616
    v_mfma_f32_16x16x32_bf16 v[48:51], a[112:115], v[224:227], 0
    ds_read_b64_tr_b16 a[136:137], v3 offset:768
    ds_read_b64_tr_b16 a[138:139], v3 offset:4864
    v_mfma_f32_16x16x32_bf16 v[80:83], a[112:115], v[232:235], 0
    ds_read_b64_tr_b16 a[140:141], v3 offset:776
    ds_read_b64_tr_b16 a[142:143], v3 offset:4872
    v_mfma_f32_16x16x32_bf16 v[112:115], a[112:115], v[240:243], 0
    ds_read_b64_tr_b16 a[168:169], v4 offset:0
    ds_read_b64_tr_b16 a[170:171], v4 offset:4096
    s_waitcnt lgkmcnt(14)
    v_mfma_f32_16x16x32_bf16 v[20:23], a[116:119], v[216:219], 0
    ds_read_b64_tr_b16 a[172:173], v4 offset:8
    ds_read_b64_tr_b16 a[174:175], v4 offset:4104
    v_mfma_f32_16x16x32_bf16 v[52:55], a[116:119], v[224:227], 0
    ds_read_b64_tr_b16 a[176:177], v4 offset:256
    ds_read_b64_tr_b16 a[178:179], v4 offset:4352
    v_mfma_f32_16x16x32_bf16 v[84:87], a[116:119], v[232:235], 0
    v_mfma_f32_16x16x32_bf16 v[116:119], a[116:119], v[240:243], 0
    s_waitcnt lgkmcnt(15)
    v_mfma_f32_16x16x32_bf16 v[24:27], a[120:123], v[216:219], 0
    v_mfma_f32_16x16x32_bf16 v[56:59], a[120:123], v[224:227], 0
    ds_read_b64_tr_b16 a[180:181], v4 offset:264
    ds_read_b64_tr_b16 a[182:183], v4 offset:4360
    v_mfma_f32_16x16x32_bf16 v[88:91], a[120:123], v[232:235], 0
    v_mfma_f32_16x16x32_bf16 v[120:123], a[120:123], v[240:243], 0
    s_waitcnt lgkmcnt(15)
    v_mfma_f32_16x16x32_bf16 v[28:31], a[124:127], v[216:219], 0
    v_mfma_f32_16x16x32_bf16 v[60:63], a[124:127], v[224:227], 0
    ds_read_b64_tr_b16 a[184:185], v4 offset:512
    ds_read_b64_tr_b16 a[186:187], v4 offset:4608
    v_mfma_f32_16x16x32_bf16 v[92:95], a[124:127], v[232:235], 0
    v_mfma_f32_16x16x32_bf16 v[124:127], a[124:127], v[240:243], 0
    s_waitcnt lgkmcnt(15)
    v_mfma_f32_16x16x32_bf16 v[32:35], a[128:131], v[216:219], 0
    v_mfma_f32_16x16x32_bf16 v[64:67], a[128:131], v[224:227], 0
    ds_read_b64_tr_b16 a[188:189], v4 offset:520
    ds_read_b64_tr_b16 a[190:191], v4 offset:4616
    v_mfma_f32_16x16x32_bf16 v[96:99], a[128:131], v[232:235], 0
    v_mfma_f32_16x16x32_bf16 v[128:131], a[128:131], v[240:243], 0
    s_waitcnt lgkmcnt(15)
    v_mfma_f32_16x16x32_bf16 v[36:39], a[132:135], v[216:219], 0
    v_mfma_f32_16x16x32_bf16 v[68:71], a[132:135], v[224:227], 0
    ds_read_b64_tr_b16 a[192:193], v4 offset:768
    ds_read_b64_tr_b16 a[194:195], v4 offset:4864
    v_mfma_f32_16x16x32_bf16 v[100:103], a[132:135], v[232:235], 0
    v_mfma_f32_16x16x32_bf16 v[132:135], a[132:135], v[240:243], 0
    s_waitcnt lgkmcnt(15)
    v_mfma_f32_16x16x32_bf16 v[40:43], a[136:139], v[216:219], 0
    v_mfma_f32_16x16x32_bf16 v[72:75], a[136:139], v[224:227], 0
    ds_read_b64_tr_b16 a[196:197], v4 offset:776
    ds_read_b64_tr_b16 a[198:199], v4 offset:4872
    v_mfma_f32_16x16x32_bf16 v[104:107], a[136:139], v[232:235], 0
    v_mfma_f32_16x16x32_bf16 v[136:139], a[136:139], v[240:243], 0
    s_waitcnt lgkmcnt(15)
    v_mfma_f32_16x16x32_bf16 v[44:47], a[140:143], v[216:219], 0
    v_mfma_f32_16x16x32_bf16 v[76:79], a[140:143], v[224:227], 0
    v_mfma_f32_16x16x32_bf16 v[108:111], a[140:143], v[232:235], 0
    v_mfma_f32_16x16x32_bf16 v[140:143], a[140:143], v[240:243], 0
    s_waitcnt vmcnt(4)
    s_add_u32 m0, s45, 49152
    s_add_u32 s95, s94, 16384
    s_and_b32 s95, s95, 0x1ffff
    v_mfma_f32_16x16x32_bf16 a[144:147], a[164:167], v[220:223], a[144:147]
    ds_read_b128 v[144:147], v11 offset:0
    ds_read_b128 v[148:151], v11 offset:256
    ds_read_b128 v[152:155], v11 offset:512
    v_mfma_f32_16x16x32_bf16 a[148:151], a[164:167], v[228:231], a[148:151]
    buffer_load_dwordx4 v5, s[20:23], s95 offen nt lds
    ds_read_b128 v[156:159], v11 offset:768
    v_mfma_f32_16x16x32_bf16 a[152:155], a[164:167], v[236:239], a[152:155]
    buffer_load_dwordx4 v6, s[20:23], s95 offen offset:1024 nt lds
    v_mfma_f32_16x16x32_bf16 a[156:159], a[164:167], v[244:247], a[156:159]
    buffer_load_dwordx4 v7, s[20:23], s95 offen offset:2048 nt lds
    s_waitcnt lgkmcnt(15)
    v_mfma_f32_16x16x32_bf16 v[16:19], a[168:171], v[220:223], v[16:19]
    buffer_load_dwordx4 v8, s[20:23], s95 offen offset:3072 nt lds
    v_mfma_f32_16x16x32_bf16 v[48:51], a[168:171], v[228:231], v[48:51]
    s_waitcnt lgkmcnt(3)
    v_lshlrev_b32 v160, 16, v144
    v_and_b32 v161, s47, v144
    v_lshlrev_b32 v162, 16, v145
    v_mfma_f32_16x16x32_bf16 v[80:83], a[168:171], v[236:239], v[80:83]
    v_and_b32 v163, s47, v145
    v_mul_f32 v160, s48, v160
    v_mul_f32 v161, s48, v161
    v_mfma_f32_16x16x32_bf16 v[112:115], a[168:171], v[244:247], v[112:115]
    v_mul_f32 v162, s48, v162
    v_mul_f32 v163, s48, v163
    v_cvt_pk_bf16_f32 v144, v160, v161
    v_mfma_f32_16x16x32_bf16 v[20:23], a[172:175], v[220:223], v[20:23]
    v_cvt_pk_bf16_f32 v145, v162, v163
    v_accvgpr_write_b32 a64, v144
    v_accvgpr_write_b32 a65, v145
    v_mfma_f32_16x16x32_bf16 v[52:55], a[172:175], v[228:231], v[52:55]
    v_lshlrev_b32 v164, 16, v146
    v_and_b32 v165, s47, v146
    v_lshlrev_b32 v166, 16, v147
    v_mfma_f32_16x16x32_bf16 v[84:87], a[172:175], v[236:239], v[84:87]
    v_and_b32 v167, s47, v147
    v_mul_f32 v164, s48, v164
    v_mfma_f32_16x16x32_bf16 v[116:119], a[172:175], v[244:247], v[116:119]
    v_mul_f32 v165, s48, v165
    v_mul_f32 v166, s48, v166
    v_mul_f32 v167, s48, v167
    v_mfma_f32_16x16x32_bf16 v[24:27], a[176:179], v[220:223], v[24:27]
    v_cvt_pk_bf16_f32 v146, v164, v165
    v_cvt_pk_bf16_f32 v147, v166, v167
    v_accvgpr_write_b32 a66, v146
    v_mfma_f32_16x16x32_bf16 v[56:59], a[176:179], v[228:231], v[56:59]
    v_accvgpr_write_b32 a67, v147
    s_waitcnt lgkmcnt(2)
    v_lshlrev_b32 v168, 16, v148
    v_and_b32 v169, s47, v148
    v_mfma_f32_16x16x32_bf16 v[88:91], a[176:179], v[236:239], v[88:91]
    v_lshlrev_b32 v170, 16, v149
    v_and_b32 v171, s47, v149
    v_mul_f32 v168, s48, v168
    v_mfma_f32_16x16x32_bf16 v[120:123], a[176:179], v[244:247], v[120:123]
    v_mul_f32 v169, s48, v169
    v_mul_f32 v170, s48, v170
    v_mfma_f32_16x16x32_bf16 v[28:31], a[180:183], v[220:223], v[28:31]
    v_mul_f32 v171, s48, v171
    v_cvt_pk_bf16_f32 v148, v168, v169
    v_cvt_pk_bf16_f32 v149, v170, v171
    v_mfma_f32_16x16x32_bf16 v[60:63], a[180:183], v[228:231], v[60:63]
    v_accvgpr_write_b32 a68, v148
    v_accvgpr_write_b32 a69, v149
    v_lshlrev_b32 v172, 16, v150
    v_mfma_f32_16x16x32_bf16 v[92:95], a[180:183], v[236:239], v[92:95]
    v_and_b32 v173, s47, v150
    v_lshlrev_b32 v174, 16, v151
    v_and_b32 v175, s47, v151
    v_mfma_f32_16x16x32_bf16 v[124:127], a[180:183], v[244:247], v[124:127]
    v_mul_f32 v172, s48, v172
    v_mul_f32 v173, s48, v173
    v_mul_f32 v174, s48, v174
    v_mfma_f32_16x16x32_bf16 v[32:35], a[184:187], v[220:223], v[32:35]
    v_mul_f32 v175, s48, v175
    v_cvt_pk_bf16_f32 v150, v172, v173
    v_mfma_f32_16x16x32_bf16 v[64:67], a[184:187], v[228:231], v[64:67]
    v_cvt_pk_bf16_f32 v151, v174, v175
    v_accvgpr_write_b32 a70, v150
    v_accvgpr_write_b32 a71, v151
    v_mfma_f32_16x16x32_bf16 v[96:99], a[184:187], v[236:239], v[96:99]
    s_waitcnt lgkmcnt(1)
    v_lshlrev_b32 v160, 16, v152
    v_and_b32 v161, s47, v152
    v_lshlrev_b32 v162, 16, v153
    v_mfma_f32_16x16x32_bf16 v[128:131], a[184:187], v[244:247], v[128:131]
    v_and_b32 v163, s47, v153
    v_mul_f32 v160, s48, v160
    v_mul_f32 v161, s48, v161
    v_mfma_f32_16x16x32_bf16 v[36:39], a[188:191], v[220:223], v[36:39]
    v_mul_f32 v162, s48, v162
    v_mul_f32 v163, s48, v163
    v_cvt_pk_bf16_f32 v152, v160, v161
    v_mfma_f32_16x16x32_bf16 v[68:71], a[188:191], v[228:231], v[68:71]
    v_cvt_pk_bf16_f32 v153, v162, v163
    v_accvgpr_write_b32 a72, v152
    v_mfma_f32_16x16x32_bf16 v[100:103], a[188:191], v[236:239], v[100:103]
    v_accvgpr_write_b32 a73, v153
    v_lshlrev_b32 v164, 16, v154
    v_and_b32 v165, s47, v154
    v_mfma_f32_16x16x32_bf16 v[132:135], a[188:191], v[244:247], v[132:135]
    v_lshlrev_b32 v166, 16, v155
    v_and_b32 v167, s47, v155
    v_mul_f32 v164, s48, v164
    v_mfma_f32_16x16x32_bf16 v[40:43], a[192:195], v[220:223], v[40:43]
    v_mul_f32 v165, s48, v165
    v_mul_f32 v166, s48, v166
    v_mul_f32 v167, s48, v167
    v_mfma_f32_16x16x32_bf16 v[72:75], a[192:195], v[228:231], v[72:75]
    v_cvt_pk_bf16_f32 v154, v164, v165
    v_cvt_pk_bf16_f32 v155, v166, v167
    v_accvgpr_write_b32 a74, v154
    v_mfma_f32_16x16x32_bf16 v[104:107], a[192:195], v[236:239], v[104:107]
    v_accvgpr_write_b32 a75, v155
    s_waitcnt lgkmcnt(0)
    v_lshlrev_b32 v168, 16, v156
    v_and_b32 v169, s47, v156
    v_mfma_f32_16x16x32_bf16 v[136:139], a[192:195], v[244:247], v[136:139]
    v_lshlrev_b32 v170, 16, v157
    v_and_b32 v171, s47, v157
    v_mfma_f32_16x16x32_bf16 v[44:47], a[196:199], v[220:223], v[44:47]
    v_mul_f32 v168, s48, v168
    v_mul_f32 v169, s48, v169
    v_mul_f32 v170, s48, v170
    v_mfma_f32_16x16x32_bf16 v[76:79], a[196:199], v[228:231], v[76:79]
    v_mul_f32 v171, s48, v171
    v_cvt_pk_bf16_f32 v156, v168, v169
    v_cvt_pk_bf16_f32 v157, v170, v171
    v_mfma_f32_16x16x32_bf16 v[108:111], a[196:199], v[236:239], v[108:111]
    v_accvgpr_write_b32 a76, v156
    v_accvgpr_write_b32 a77, v157
    v_lshlrev_b32 v172, 16, v158
    v_mfma_f32_16x16x32_bf16 v[140:143], a[196:199], v[244:247], v[140:143]
    v_and_b32 v173, s47, v158
    v_lshlrev_b32 v174, 16, v159
    v_and_b32 v175, s47, v159
    v_mfma_f32_16x16x32_bf16 v[200:203], a[80:83], a[64:67], -4.0
    v_mul_f32 v172, s48, v172
    v_mul_f32 v173, s48, v173
    v_mfma_f32_16x16x32_bf16 v[200:203], a[84:87], a[68:71], v[200:203]
    v_mul_f32 v174, s48, v174
    v_mul_f32 v175, s48, v175
    v_cvt_pk_bf16_f32 v158, v172, v173
    v_mfma_f32_16x16x32_bf16 v[200:203], a[88:91], a[72:75], v[200:203]
    v_cvt_pk_bf16_f32 v159, v174, v175
    v_accvgpr_write_b32 a78, v158
    v_accvgpr_write_b32 a79, v159
    s_nop 1
    v_mfma_f32_16x16x32_bf16 v[200:203], a[92:95], a[76:79], v[200:203]
    v_mfma_f32_16x16x32_bf16 v[204:207], a[96:99], a[64:67], -4.0
    v_mfma_f32_16x16x32_bf16 v[204:207], a[100:103], a[68:71], v[204:207]
    v_exp_f32 v200, v200
    v_exp_f32 v201, v201
    v_mfma_f32_16x16x32_bf16 v[204:207], a[104:107], a[72:75], v[204:207]
    v_exp_f32 v202, v202
    v_exp_f32 v203, v203
    v_cvt_pk_bf16_f32 v248, v200, v201
    v_mfma_f32_16x16x32_bf16 v[204:207], a[108:111], a[76:79], v[204:207]
    v_cvt_pk_bf16_f32 v249, v202, v203
    s_waitcnt vmcnt(4)
    s_add_u32 m0, s45, 65536
    s_add_u32 s95, s94, 32768
    s_and_b32 s95, s95, 0x1ffff
    buffer_load_dwordx4 v5, s[16:19], s95 offen nt lds
    buffer_load_dwordx4 v6, s[16:19], s95 offen offset:1024 nt lds
    buffer_load_dwordx4 v7, s[16:19], s95 offen offset:2048 nt lds
    buffer_load_dwordx4 v8, s[16:19], s95 offen offset:3072 nt lds
    s_waitcnt vmcnt(8)
    s_barrier
    ds_read_b128 a[200:203], v1 offset:32768
    ds_read_b128 a[204:207], v1 offset:33024
    ds_read_b128 a[208:211], v1 offset:33280
    ds_read_b128 a[212:215], v1 offset:33536
    s_waitcnt lgkmcnt(3)
    v_mfma_f32_16x16x32_bf16 v[208:211], a[200:203], a[0:3], -4.0
    ds_read_b128 a[216:219], v1 offset:36864
    ds_read_b128 a[220:223], v1 offset:37120
    s_waitcnt lgkmcnt(4)
    v_mfma_f32_16x16x32_bf16 v[208:211], a[204:207], a[4:7], v[208:211]
    ds_read_b128 a[224:227], v1 offset:37376
    ds_read_b128 a[228:231], v1 offset:37632
    s_waitcnt lgkmcnt(5)
    v_mfma_f32_16x16x32_bf16 v[208:211], a[208:211], a[8:11], v[208:211]
    v_exp_f32 v204, v204
    s_waitcnt lgkmcnt(4)
    v_mfma_f32_16x16x32_bf16 v[208:211], a[212:215], a[12:15], v[208:211]
    v_exp_f32 v205, v205
    v_mfma_f32_16x16x32_bf16 v[176:179], a[200:203], a[16:19], -4.0
    v_exp_f32 v206, v206
    v_mfma_f32_16x16x32_bf16 v[176:179], a[204:207], a[20:23], v[176:179]
    v_exp_f32 v207, v207
    v_mfma_f32_16x16x32_bf16 v[176:179], a[208:211], a[24:27], v[176:179]
    v_cvt_pk_bf16_f32 v250, v204, v205
    v_cvt_pk_bf16_f32 v251, v206, v207
    v_mfma_f32_16x16x32_bf16 v[176:179], a[212:215], a[28:31], v[176:179]
    v_exp_f32 v208, v208
    v_mfma_f32_16x16x32_bf16 v[184:187], a[200:203], a[32:35], -4.0
    v_exp_f32 v209, v209
    v_mfma_f32_16x16x32_bf16 v[184:187], a[204:207], a[36:39], v[184:187]
    ds_read_b128 a[80:83], v2 offset:32768
    v_exp_f32 v176, v176
    v_mfma_f32_16x16x32_bf16 v[184:187], a[208:211], a[40:43], v[184:187]
    v_exp_f32 v177, v177
    v_mfma_f32_16x16x32_bf16 v[184:187], a[212:215], a[44:47], v[184:187]
    v_exp_f32 v210, v210
    v_mfma_f32_16x16x32_bf16 v[192:195], a[200:203], a[48:51], -4.0
    v_exp_f32 v178, v178
    v_mfma_f32_16x16x32_bf16 v[192:195], a[204:207], a[52:55], v[192:195]
    v_exp_f32 v184, v184
    ds_read_b128 a[84:87], v2 offset:33024
    v_mfma_f32_16x16x32_bf16 v[192:195], a[208:211], a[56:59], v[192:195]
    v_exp_f32 v185, v185
    v_mfma_f32_16x16x32_bf16 v[192:195], a[212:215], a[60:63], v[192:195]
    v_exp_f32 v186, v186
    s_waitcnt lgkmcnt(5)
    v_mfma_f32_16x16x32_bf16 v[212:215], a[216:219], a[0:3], -4.0
    v_exp_f32 v211, v211
    v_cvt_pk_bf16_f32 v216, v208, v209
    s_waitcnt lgkmcnt(4)
    v_mfma_f32_16x16x32_bf16 v[212:215], a[220:223], a[4:7], v[212:215]
    v_exp_f32 v192, v192
    ds_read_b128 a[88:91], v2 offset:33280
    s_waitcnt lgkmcnt(4)
    v_mfma_f32_16x16x32_bf16 v[212:215], a[224:227], a[8:11], v[212:215]
    v_exp_f32 v193, v193
    s_waitcnt lgkmcnt(3)
    v_mfma_f32_16x16x32_bf16 v[212:215], a[228:231], a[12:15], v[212:215]
    v_exp_f32 v194, v194
    v_cvt_pk_bf16_f32 v217, v210, v211
    v_mfma_f32_16x16x32_bf16 v[180:183], a[216:219], a[16:19], -4.0
    v_exp_f32 v179, v179
    v_cvt_pk_bf16_f32 v224, v176, v177
    v_mfma_f32_16x16x32_bf16 v[180:183], a[220:223], a[20:23], v[180:183]
    v_exp_f32 v212, v212
    v_mfma_f32_16x16x32_bf16 v[180:183], a[224:227], a[24:27], v[180:183]
    v_exp_f32 v213, v213
    ds_read_b128 a[92:95], v2 offset:33536
    v_mfma_f32_16x16x32_bf16 v[180:183], a[228:231], a[28:31], v[180:183]
    v_exp_f32 v214, v214
    v_cvt_pk_bf16_f32 v225, v178, v179
    v_mfma_f32_16x16x32_bf16 v[188:191], a[216:219], a[32:35], -4.0
    v_exp_f32 v215, v215
    v_mfma_f32_16x16x32_bf16 v[188:191], a[220:223], a[36:39], v[188:191]
    v_exp_f32 v180, v180
    ds_read_b128 a[96:99], v2 offset:36864
    v_mfma_f32_16x16x32_bf16 v[188:191], a[224:227], a[40:43], v[188:191]
    v_exp_f32 v181, v181
    v_cvt_pk_bf16_f32 v218, v212, v213
    v_mfma_f32_16x16x32_bf16 v[188:191], a[228:231], a[44:47], v[188:191]
    v_exp_f32 v182, v182
    v_mfma_f32_16x16x32_bf16 v[196:199], a[216:219], a[48:51], -4.0
    v_exp_f32 v183, v183
    v_cvt_pk_bf16_f32 v226, v180, v181
    v_mfma_f32_16x16x32_bf16 v[196:199], a[220:223], a[52:55], v[196:199]
    v_exp_f32 v188, v188
    ds_read_b128 a[100:103], v2 offset:37120
    v_mfma_f32_16x16x32_bf16 v[196:199], a[224:227], a[56:59], v[196:199]
    v_exp_f32 v189, v189
    v_mfma_f32_16x16x32_bf16 v[196:199], a[228:231], a[60:63], v[196:199]
    v_exp_f32 v190, v190
    v_cvt_pk_bf16_f32 v219, v214, v215
    v_mfma_f32_16x16x32_bf16 a[160:163], a[164:167], v[248:251], 0
    v_exp_f32 v187, v187
    v_cvt_pk_bf16_f32 v232, v184, v185
    v_mfma_f32_16x16x32_bf16 v[144:147], a[112:115], v[248:251], 0
    v_exp_f32 v196, v196
    v_mfma_f32_16x16x32_bf16 v[148:151], a[116:119], v[248:251], 0
    v_exp_f32 v197, v197
    ds_read_b128 a[104:107], v2 offset:37376
    v_mfma_f32_16x16x32_bf16 v[152:155], a[120:123], v[248:251], 0
    v_exp_f32 v198, v198
    v_cvt_pk_bf16_f32 v227, v182, v183
    v_mfma_f32_16x16x32_bf16 v[156:159], a[124:127], v[248:251], 0
    v_exp_f32 v191, v191
    v_mfma_f32_16x16x32_bf16 v[160:163], a[128:131], v[248:251], 0
    v_exp_f32 v195, v195
    v_cvt_pk_bf16_f32 v234, v188, v189
    v_mfma_f32_16x16x32_bf16 v[164:167], a[132:135], v[248:251], 0
    v_exp_f32 v199, v199
    v_mfma_f32_16x16x32_bf16 v[168:171], a[136:139], v[248:251], 0
    v_cvt_pk_bf16_f32 v240, v192, v193
    v_cvt_pk_bf16_f32 v242, v196, v197
    ds_read_b128 a[108:111], v2 offset:37632
    v_mfma_f32_16x16x32_bf16 v[172:175], a[140:143], v[248:251], 0
    v_cvt_pk_bf16_f32 v233, v186, v187
    v_cvt_pk_bf16_f32 v235, v190, v191
    v_cvt_pk_bf16_f32 v241, v194, v195
    v_mfma_f32_16x16x32_bf16 v[200:203], a[200:203], a[64:67], -4.0
    v_cvt_pk_bf16_f32 v243, v198, v199
    v_mfma_f32_16x16x32_bf16 v[200:203], a[204:207], a[68:71], v[200:203]
    v_mfma_f32_16x16x32_bf16 v[200:203], a[208:211], a[72:75], v[200:203]
    v_mfma_f32_16x16x32_bf16 v[200:203], a[212:215], a[76:79], v[200:203]
    v_mfma_f32_16x16x32_bf16 v[204:207], a[216:219], a[64:67], -4.0
    v_mfma_f32_16x16x32_bf16 v[204:207], a[220:223], a[68:71], v[204:207]
    v_exp_f32 v200, v200
    v_exp_f32 v201, v201
    v_exp_f32 v202, v202
    v_mfma_f32_16x16x32_bf16 v[204:207], a[224:227], a[72:75], v[204:207]
    v_exp_f32 v203, v203
    v_cvt_pk_bf16_f32 v248, v200, v201
    v_cvt_pk_bf16_f32 v249, v202, v203
    v_mfma_f32_16x16x32_bf16 v[204:207], a[228:231], a[76:79], v[204:207]
    s_nop 7
    v_exp_f32 v204, v204
    v_exp_f32 v205, v205
    v_exp_f32 v206, v206
    v_exp_f32 v207, v207
    v_cvt_pk_bf16_f32 v250, v204, v205
    v_cvt_pk_bf16_f32 v251, v206, v207
    v_add_u32 v1, 65536, v1
    v_add_u32 v2, 65536, v2
    v_add_u32 v3, 32768, v3
    v_add_u32 v4, 32768, v4
    s_add_u32 m0, s45, 81920
    s_add_u32 s95, s94, 32768
    s_and_b32 s95, s95, 0x1ffff
    buffer_load_dwordx4 v5, s[20:23], s95 offen nt lds
    buffer_load_dwordx4 v6, s[20:23], s95 offen offset:1024 nt lds
    buffer_load_dwordx4 v7, s[20:23], s95 offen offset:2048 nt lds
    buffer_load_dwordx4 v8, s[20:23], s95 offen offset:3072 nt lds
    s_add_u32 m0, s45, 98304
    s_add_u32 s95, s94, 49152
    s_and_b32 s95, s95, 0x1ffff
    buffer_load_dwordx4 v5, s[16:19], s95 offen nt lds
    buffer_load_dwordx4 v6, s[16:19], s95 offen offset:1024 nt lds
    buffer_load_dwordx4 v7, s[16:19], s95 offen offset:2048 nt lds
    buffer_load_dwordx4 v8, s[16:19], s95 offen offset:3072 nt lds
    s_waitcnt vmcnt(12)
    s_waitcnt lgkmcnt(0)
    s_barrier
    s_mov_b64 vcc, 0
    s_branch L_body
L_g2:
    s_waitcnt vmcnt(8)
    s_barrier
    s_mov_b64 vcc, -1
    s_nop 3
    s_branch L_g2ret
L_loop:
    s_waitcnt vmcnt(8) lgkmcnt(0)
    s_barrier
L_body:
    v_mfma_f32_16x16x32_bf16 v[176:179], a[80:83], a[0:3], -4.0
    s_mov_b32 m0, s33
    v_mfma_f32_16x16x32_bf16 v[184:187], a[80:83], a[16:19], -4.0
    s_cmp_ge_u32 s33, 131072
    s_cselect_b32 s42, s41, s40
    v_mfma_f32_16x16x32_bf16 v[176:179], a[84:87], a[4:7], v[176:179]
    s_cmp_ge_u32 s38, 131072
    s_cselect_b32 s35, s41, s40
    v_mfma_f32_16x16x32_bf16 v[184:187], a[84:87], a[20:23], v[184:187]
    ds_read_b64_tr_b16 a[112:113], v3 offset:0
    s_add_u32 s38, s38, s35
    v_mfma_f32_16x16x32_bf16 v[176:179], a[88:91], a[8:11], v[176:179]
    ds_read_b64_tr_b16 a[114:115], v3 offset:4096
    v_mfma_f32_16x16x32_bf16 v[184:187], a[88:91], a[24:27], v[184:187]
    ds_read_b64_tr_b16 a[116:117], v3 offset:8
    v_mfma_f32_16x16x32_bf16 v[176:179], a[92:95], a[12:15], v[176:179]
    ds_read_b64_tr_b16 a[118:119], v3 offset:4104
    v_mfma_f32_16x16x32_bf16 v[184:187], a[92:95], a[28:31], v[184:187]
    ds_read_b64_tr_b16 a[120:121], v3 offset:256
    v_mfma_f32_16x16x32_bf16 v[192:195], a[80:83], a[32:35], -4.0
    ds_read_b64_tr_b16 a[122:123], v3 offset:4352
    v_mfma_f32_16x16x32_bf16 v[200:203], a[80:83], a[48:51], -4.0
    v_exp_f32 v176, v176
    v_mfma_f32_16x16x32_bf16 v[192:195], a[84:87], a[36:39], v[192:195]
    v_exp_f32 v177, v177
    v_mfma_f32_16x16x32_bf16 v[200:203], a[84:87], a[52:55], v[200:203]
    ds_read_b64_tr_b16 a[124:125], v3 offset:264
    v_cvt_pk_bf16_f32 v220, v176, v177
    v_mfma_f32_16x16x32_bf16 v[192:195], a[88:91], a[40:43], v[192:195]
    v_exp_f32 v178, v178
    v_mfma_f32_16x16x32_bf16 v[200:203], a[88:91], a[56:59], v[200:203]
    v_exp_f32 v179, v179
    v_mfma_f32_16x16x32_bf16 v[192:195], a[92:95], a[44:47], v[192:195]
    ds_read_b64_tr_b16 a[126:127], v3 offset:4360
    v_cvt_pk_bf16_f32 v221, v178, v179
    v_mfma_f32_16x16x32_bf16 v[200:203], a[92:95], a[60:63], v[200:203]
    v_exp_f32 v184, v184
    v_mfma_f32_16x16x32_bf16 v[180:183], a[96:99], a[0:3], -4.0
    v_exp_f32 v185, v185
    v_mfma_f32_16x16x32_bf16 v[188:191], a[96:99], a[16:19], -4.0
    ds_read_b64_tr_b16 a[128:129], v3 offset:512
    v_cvt_pk_bf16_f32 v228, v184, v185
    v_mfma_f32_16x16x32_bf16 v[180:183], a[100:103], a[4:7], v[180:183]
    v_exp_f32 v186, v186
    v_mfma_f32_16x16x32_bf16 v[188:191], a[100:103], a[20:23], v[188:191]
    v_exp_f32 v187, v187
    v_mfma_f32_16x16x32_bf16 v[180:183], a[104:107], a[8:11], v[180:183]
    ds_read_b64_tr_b16 a[130:131], v3 offset:4608
    v_cvt_pk_bf16_f32 v229, v186, v187
    v_mfma_f32_16x16x32_bf16 v[188:191], a[104:107], a[24:27], v[188:191]
    v_exp_f32 v192, v192
    v_mfma_f32_16x16x32_bf16 v[180:183], a[108:111], a[12:15], v[180:183]
    v_exp_f32 v193, v193
    v_mfma_f32_16x16x32_bf16 v[188:191], a[108:111], a[28:31], v[188:191]
    ds_read_b64_tr_b16 a[132:133], v3 offset:520
    v_cvt_pk_bf16_f32 v236, v192, v193
    v_mfma_f32_16x16x32_bf16 v[196:199], a[96:99], a[32:35], -4.0
    v_exp_f32 v194, v194
    v_mfma_f32_16x16x32_bf16 v[204:207], a[96:99], a[48:51], -4.0
    v_exp_f32 v195, v195
    v_mfma_f32_16x16x32_bf16 v[196:199], a[100:103], a[36:39], v[196:199]
    ds_read_b64_tr_b16 a[134:135], v3 offset:4616
    v_cvt_pk_bf16_f32 v237, v194, v195
    v_mfma_f32_16x16x32_bf16 v[204:207], a[100:103], a[52:55], v[204:207]
    v_exp_f32 v200, v200
    v_mfma_f32_16x16x32_bf16 v[196:199], a[104:107], a[40:43], v[196:199]
    v_exp_f32 v201, v201
    v_mfma_f32_16x16x32_bf16 v[204:207], a[104:107], a[56:59], v[204:207]
    ds_read_b64_tr_b16 a[136:137], v3 offset:768
    v_cvt_pk_bf16_f32 v244, v200, v201
    v_mfma_f32_16x16x32_bf16 v[196:199], a[108:111], a[44:47], v[196:199]
    v_exp_f32 v202, v202
    v_mfma_f32_16x16x32_bf16 v[204:207], a[108:111], a[60:63], v[204:207]
    v_exp_f32 v203, v203
    s_cbranch_vccz L_g2
L_g2ret:
    v_mfma_f32_16x16x32_bf16 a[160:163], a[164:167], v[248:251], a[160:163]
    ds_read_b64_tr_b16 a[138:139], v3 offset:4864
    v_cvt_pk_bf16_f32 v245, v202, v203
    s_waitcnt lgkmcnt(2)
    v_mfma_f32_16x16x32_bf16 v[16:19], a[112:115], v[216:219], v[16:19]
    v_exp_f32 v180, v180
    v_mfma_f32_16x16x32_bf16 v[48:51], a[112:115], v[224:227], v[48:51]
    v_exp_f32 v181, v181
    v_mfma_f32_16x16x32_bf16 v[80:83], a[112:115], v[232:235], v[80:83]
    ds_read_b64_tr_b16 a[140:141], v3 offset:776
    v_cvt_pk_bf16_f32 v222, v180, v181
    v_mfma_f32_16x16x32_bf16 v[112:115], a[112:115], v[240:243], v[112:115]
    v_exp_f32 v182, v182
    v_mfma_f32_16x16x32_bf16 v[144:147], a[112:115], v[248:251], v[144:147]
    v_exp_f32 v183, v183
    v_mfma_f32_16x16x32_bf16 v[20:23], a[116:119], v[216:219], v[20:23]
    ds_read_b64_tr_b16 a[142:143], v3 offset:4872
    v_cvt_pk_bf16_f32 v223, v182, v183
    v_mfma_f32_16x16x32_bf16 v[52:55], a[116:119], v[224:227], v[52:55]
    ds_read_b128 a[80:83], v1 offset:0
    v_add_u32 v3, s35, v3
    v_mfma_f32_16x16x32_bf16 v[84:87], a[116:119], v[232:235], v[84:87]
    v_exp_f32 v188, v188
    v_mfma_f32_16x16x32_bf16 v[116:119], a[116:119], v[240:243], v[116:119]
    v_exp_f32 v189, v189
    v_mfma_f32_16x16x32_bf16 v[148:151], a[116:119], v[248:251], v[148:151]
    ds_read_b128 a[84:87], v1 offset:256
    v_cvt_pk_bf16_f32 v230, v188, v189
    v_mfma_f32_16x16x32_bf16 v[24:27], a[120:123], v[216:219], v[24:27]
    v_exp_f32 v190, v190
    v_mfma_f32_16x16x32_bf16 v[56:59], a[120:123], v[224:227], v[56:59]
    v_exp_f32 v191, v191
    v_mfma_f32_16x16x32_bf16 v[88:91], a[120:123], v[232:235], v[88:91]
    ds_read_b128 a[88:91], v1 offset:512
    v_cvt_pk_bf16_f32 v231, v190, v191
    v_mfma_f32_16x16x32_bf16 v[120:123], a[120:123], v[240:243], v[120:123]
    v_exp_f32 v196, v196
    v_mfma_f32_16x16x32_bf16 v[152:155], a[120:123], v[248:251], v[152:155]
    v_exp_f32 v197, v197
    v_mfma_f32_16x16x32_bf16 v[28:31], a[124:127], v[216:219], v[28:31]
    ds_read_b128 a[92:95], v1 offset:768
    v_cvt_pk_bf16_f32 v238, v196, v197
    v_mfma_f32_16x16x32_bf16 v[60:63], a[124:127], v[224:227], v[60:63]
    v_exp_f32 v198, v198
    v_mfma_f32_16x16x32_bf16 v[92:95], a[124:127], v[232:235], v[92:95]
    v_exp_f32 v199, v199
    v_mfma_f32_16x16x32_bf16 v[124:127], a[124:127], v[240:243], v[124:127]
    ds_read_b128 a[96:99], v1 offset:4096
    v_cvt_pk_bf16_f32 v239, v198, v199
    v_mfma_f32_16x16x32_bf16 v[156:159], a[124:127], v[248:251], v[156:159]
    v_exp_f32 v204, v204
    v_mfma_f32_16x16x32_bf16 v[32:35], a[128:131], v[216:219], v[32:35]
    v_exp_f32 v205, v205
    v_mfma_f32_16x16x32_bf16 v[64:67], a[128:131], v[224:227], v[64:67]
    ds_read_b128 a[100:103], v1 offset:4352
    v_cvt_pk_bf16_f32 v246, v204, v205
    v_mfma_f32_16x16x32_bf16 v[96:99], a[128:131], v[232:235], v[96:99]
    v_exp_f32 v206, v206
    v_mfma_f32_16x16x32_bf16 v[128:131], a[128:131], v[240:243], v[128:131]
    v_exp_f32 v207, v207
    v_mfma_f32_16x16x32_bf16 v[160:163], a[128:131], v[248:251], v[160:163]
    ds_read_b128 a[104:107], v1 offset:4608
    v_cvt_pk_bf16_f32 v247, v206, v207
    v_mfma_f32_16x16x32_bf16 v[36:39], a[132:135], v[216:219], v[36:39]
    ds_read_b128 a[108:111], v1 offset:4864
    v_mfma_f32_16x16x32_bf16 v[68:71], a[132:135], v[224:227], v[68:71]
    v_mfma_f32_16x16x32_bf16 v[100:103], a[132:135], v[232:235], v[100:103]
    buffer_load_dwordx4 v5, s[20:23], s37 offen nt lds
    v_mfma_f32_16x16x32_bf16 v[132:135], a[132:135], v[240:243], v[132:135]
    v_mfma_f32_16x16x32_bf16 v[164:167], a[132:135], v[248:251], v[164:167]
    s_waitcnt lgkmcnt(2)
    v_mfma_f32_16x16x32_bf16 v[40:43], a[136:139], v[216:219], v[40:43]
    buffer_load_dwordx4 v6, s[20:23], s37 offen offset:1024 nt lds
    v_mfma_f32_16x16x32_bf16 v[72:75], a[136:139], v[224:227], v[72:75]
    v_mfma_f32_16x16x32_bf16 v[104:107], a[136:139], v[232:235], v[104:107]
    v_mfma_f32_16x16x32_bf16 v[136:139], a[136:139], v[240:243], v[136:139]
    buffer_load_dwordx4 v7, s[20:23], s37 offen offset:2048 nt lds
    v_mfma_f32_16x16x32_bf16 v[168:171], a[136:139], v[248:251], v[168:171]
    v_mfma_f32_16x16x32_bf16 v[44:47], a[140:143], v[216:219], v[44:47]
    v_mfma_f32_16x16x32_bf16 v[76:79], a[140:143], v[224:227], v[76:79]
    buffer_load_dwordx4 v8, s[20:23], s37 offen offset:3072 nt lds
    v_mfma_f32_16x16x32_bf16 v[108:111], a[140:143], v[232:235], v[108:111]
    s_add_u32 s37, s37, 16384
    s_and_b32 s37, s37, 0x1ffff
    v_mfma_f32_16x16x32_bf16 v[140:143], a[140:143], v[240:243], v[140:143]
    s_add_u32 s33, s33, s42
    v_mfma_f32_16x16x32_bf16 v[172:175], a[140:143], v[248:251], v[172:175]
    v_smfmac_f32_16x16x64_bf16 a[144:147], a[232:235], v[216:223], v14
    ds_read_b64_tr_b16 a[112:113], v4 offset:0
    s_mov_b32 m0, s32
    v_smfmac_f32_16x16x64_bf16 a[148:151], a[232:235], v[224:231], v14
    buffer_load_dwordx4 v5, s[16:19], s36 offen nt lds
    v_smfmac_f32_16x16x64_bf16 a[152:155], a[232:235], v[232:239], v14
    s_cmp_ge_u32 s32, 131072
    s_cselect_b32 s42, s41, s40
    v_smfmac_f32_16x16x64_bf16 a[156:159], a[232:235], v[240:247], v14
    s_cmp_ge_u32 s39, 131072
    s_cselect_b32 s34, s41, s40
    v_mfma_f32_16x16x32_bf16 v[176:179], a[80:83], a[0:3], -4.0
    ds_read_b64_tr_b16 a[114:115], v4 offset:4096
    s_add_u32 s39, s39, s34
    v_mfma_f32_16x16x32_bf16 v[184:187], a[80:83], a[16:19], -4.0
    ds_read_b64_tr_b16 a[116:117], v4 offset:8
    v_add_u32 v1, s34, v1
    v_mfma_f32_16x16x32_bf16 v[176:179], a[84:87], a[4:7], v[176:179]
    buffer_load_dwordx4 v6, s[16:19], s36 offen offset:1024 nt lds
    v_mfma_f32_16x16x32_bf16 v[184:187], a[84:87], a[20:23], v[184:187]
    ds_read_b64_tr_b16 a[118:119], v4 offset:4104
    s_add_u32 s31, s31, 1
    v_mfma_f32_16x16x32_bf16 v[176:179], a[88:91], a[8:11], v[176:179]
    ds_read_b64_tr_b16 a[120:121], v4 offset:256
    v_mfma_f32_16x16x32_bf16 v[184:187], a[88:91], a[24:27], v[184:187]
    ds_read_b64_tr_b16 a[122:123], v4 offset:4352
    v_mfma_f32_16x16x32_bf16 v[176:179], a[92:95], a[12:15], v[176:179]
    ds_read_b64_tr_b16 a[124:125], v4 offset:264
    v_mfma_f32_16x16x32_bf16 v[184:187], a[92:95], a[28:31], v[184:187]
    buffer_load_dwordx4 v7, s[16:19], s36 offen offset:2048 nt lds
    v_mfma_f32_16x16x32_bf16 v[192:195], a[80:83], a[32:35], -4.0
    ds_read_b64_tr_b16 a[126:127], v4 offset:4360
    v_mfma_f32_16x16x32_bf16 v[200:203], a[80:83], a[48:51], -4.0
    v_exp_f32 v176, v176
    v_mfma_f32_16x16x32_bf16 v[192:195], a[84:87], a[36:39], v[192:195]
    v_exp_f32 v177, v177
    v_mfma_f32_16x16x32_bf16 v[200:203], a[84:87], a[52:55], v[200:203]
    ds_read_b64_tr_b16 a[128:129], v4 offset:512
    v_cvt_pk_bf16_f32 v216, v176, v177
    v_mfma_f32_16x16x32_bf16 v[192:195], a[88:91], a[40:43], v[192:195]
    buffer_load_dwordx4 v8, s[16:19], s36 offen offset:3072 nt lds
    v_mfma_f32_16x16x32_bf16 v[200:203], a[88:91], a[56:59], v[200:203]
    ds_read_b64_tr_b16 a[130:131], v4 offset:4608
    s_add_u32 s36, s36, 16384
    v_mfma_f32_16x16x32_bf16 v[192:195], a[92:95], a[44:47], v[192:195]
    ds_read_b64_tr_b16 a[132:133], v4 offset:520
    s_and_b32 s36, s36, 0x1ffff
    v_mfma_f32_16x16x32_bf16 v[200:203], a[92:95], a[60:63], v[200:203]
    ds_read_b64_tr_b16 a[134:135], v4 offset:4616
    s_add_u32 s32, s32, s42
    v_mfma_f32_16x16x32_bf16 v[208:211], a[80:83], a[64:67], -4.0
    v_exp_f32 v178, v178
    v_mfma_f32_16x16x32_bf16 v[208:211], a[84:87], a[68:71], v[208:211]
    v_exp_f32 v179, v179
    v_mfma_f32_16x16x32_bf16 v[208:211], a[88:91], a[72:75], v[208:211]
    ds_read_b64_tr_b16 a[136:137], v4 offset:768
    v_cvt_pk_bf16_f32 v217, v178, v179
    v_mfma_f32_16x16x32_bf16 v[208:211], a[92:95], a[76:79], v[208:211]
    v_exp_f32 v184, v184
    v_mfma_f32_16x16x32_bf16 v[180:183], a[96:99], a[0:3], -4.0
    v_exp_f32 v185, v185
    v_mfma_f32_16x16x32_bf16 v[188:191], a[96:99], a[16:19], -4.0
    ds_read_b64_tr_b16 a[138:139], v4 offset:4864
    v_cvt_pk_bf16_f32 v224, v184, v185
    v_mfma_f32_16x16x32_bf16 v[180:183], a[100:103], a[4:7], v[180:183]
    v_exp_f32 v186, v186
    v_mfma_f32_16x16x32_bf16 v[188:191], a[100:103], a[20:23], v[188:191]
    v_exp_f32 v187, v187
    s_waitcnt lgkmcnt(2)
    v_mfma_f32_16x16x32_bf16 v[180:183], a[104:107], a[8:11], v[180:183]
    ds_read_b128 a[80:83], v2 offset:0
    v_cvt_pk_bf16_f32 v225, v186, v187
    v_mfma_f32_16x16x32_bf16 v[188:191], a[104:107], a[24:27], v[188:191]
    v_exp_f32 v192, v192
    v_mfma_f32_16x16x32_bf16 v[180:183], a[108:111], a[12:15], v[180:183]
    v_exp_f32 v193, v193
    v_mfma_f32_16x16x32_bf16 v[188:191], a[108:111], a[28:31], v[188:191]
    ds_read_b128 a[84:87], v2 offset:256
    v_cvt_pk_bf16_f32 v232, v192, v193
    v_mfma_f32_16x16x32_bf16 v[196:199], a[96:99], a[32:35], -4.0
    v_exp_f32 v194, v194
    v_mfma_f32_16x16x32_bf16 v[204:207], a[96:99], a[48:51], -4.0
    v_exp_f32 v195, v195
    v_mfma_f32_16x16x32_bf16 v[196:199], a[100:103], a[36:39], v[196:199]
    ds_read_b64_tr_b16 a[140:141], v4 offset:776
    v_cvt_pk_bf16_f32 v233, v194, v195
    v_mfma_f32_16x16x32_bf16 v[204:207], a[100:103], a[52:55], v[204:207]
    v_exp_f32 v200, v200
    v_mfma_f32_16x16x32_bf16 v[196:199], a[104:107], a[40:43], v[196:199]
    v_exp_f32 v201, v201
    v_mfma_f32_16x16x32_bf16 v[204:207], a[104:107], a[56:59], v[204:207]
    ds_read_b128 a[88:91], v2 offset:512
    v_cvt_pk_bf16_f32 v240, v200, v201
    v_mfma_f32_16x16x32_bf16 v[196:199], a[108:111], a[44:47], v[196:199]
    v_exp_f32 v202, v202
    v_mfma_f32_16x16x32_bf16 v[204:207], a[108:111], a[60:63], v[204:207]
    v_exp_f32 v203, v203
    v_mfma_f32_16x16x32_bf16 v[212:215], a[96:99], a[64:67], -4.0
    ds_read_b64_tr_b16 a[142:143], v4 offset:4872
    v_cvt_pk_bf16_f32 v241, v202, v203
    v_mfma_f32_16x16x32_bf16 v[212:215], a[100:103], a[68:71], v[212:215]
    ds_read_b128 a[92:95], v2 offset:768
    v_add_u32 v4, s35, v4
    v_mfma_f32_16x16x32_bf16 v[212:215], a[104:107], a[72:75], v[212:215]
    v_exp_f32 v208, v208
    v_mfma_f32_16x16x32_bf16 v[212:215], a[108:111], a[76:79], v[212:215]
    v_exp_f32 v209, v209
    v_mfma_f32_16x16x32_bf16 v[16:19], a[112:115], v[220:223], v[16:19]
    ds_read_b128 a[96:99], v2 offset:4096
    v_cvt_pk_bf16_f32 v248, v208, v209
    v_mfma_f32_16x16x32_bf16 v[48:51], a[112:115], v[228:231], v[48:51]
    v_exp_f32 v210, v210
    v_mfma_f32_16x16x32_bf16 v[80:83], a[112:115], v[236:239], v[80:83]
    v_exp_f32 v211, v211
    v_mfma_f32_16x16x32_bf16 v[112:115], a[112:115], v[244:247], v[112:115]
    ds_read_b128 a[100:103], v2 offset:4352
    v_cvt_pk_bf16_f32 v249, v210, v211
    v_mfma_f32_16x16x32_bf16 v[20:23], a[116:119], v[220:223], v[20:23]
    v_exp_f32 v180, v180
    v_mfma_f32_16x16x32_bf16 v[52:55], a[116:119], v[228:231], v[52:55]
    v_exp_f32 v181, v181
    v_mfma_f32_16x16x32_bf16 v[84:87], a[116:119], v[236:239], v[84:87]
    ds_read_b128 a[104:107], v2 offset:4608
    v_cvt_pk_bf16_f32 v218, v180, v181
    v_mfma_f32_16x16x32_bf16 v[116:119], a[116:119], v[244:247], v[116:119]
    v_exp_f32 v182, v182
    v_mfma_f32_16x16x32_bf16 v[24:27], a[120:123], v[220:223], v[24:27]
    v_exp_f32 v183, v183
    v_mfma_f32_16x16x32_bf16 v[56:59], a[120:123], v[228:231], v[56:59]
    ds_read_b128 a[108:111], v2 offset:4864
    v_cvt_pk_bf16_f32 v219, v182, v183
    v_mfma_f32_16x16x32_bf16 v[88:91], a[120:123], v[236:239], v[88:91]
    v_exp_f32 v188, v188
    v_mfma_f32_16x16x32_bf16 v[120:123], a[120:123], v[244:247], v[120:123]
    v_exp_f32 v189, v189
    v_mfma_f32_16x16x32_bf16 v[28:31], a[124:127], v[220:223], v[28:31]
    v_exp_f32 v190, v190
    v_mfma_f32_16x16x32_bf16 v[60:63], a[124:127], v[228:231], v[60:63]
    v_exp_f32 v191, v191
    v_mfma_f32_16x16x32_bf16 v[92:95], a[124:127], v[236:239], v[92:95]
    v_exp_f32 v196, v196
    v_mfma_f32_16x16x32_bf16 v[124:127], a[124:127], v[244:247], v[124:127]
    v_exp_f32 v197, v197
    v_mfma_f32_16x16x32_bf16 v[32:35], a[128:131], v[220:223], v[32:35]
    v_exp_f32 v198, v198
    v_mfma_f32_16x16x32_bf16 v[64:67], a[128:131], v[228:231], v[64:67]
    v_exp_f32 v199, v199
    v_mfma_f32_16x16x32_bf16 v[96:99], a[128:131], v[236:239], v[96:99]
    v_exp_f32 v204, v204
    v_mfma_f32_16x16x32_bf16 v[128:131], a[128:131], v[244:247], v[128:131]
    v_exp_f32 v205, v205
    v_mfma_f32_16x16x32_bf16 v[36:39], a[132:135], v[220:223], v[36:39]
    v_exp_f32 v206, v206
    v_mfma_f32_16x16x32_bf16 v[68:71], a[132:135], v[228:231], v[68:71]
    v_exp_f32 v207, v207
    v_mfma_f32_16x16x32_bf16 v[100:103], a[132:135], v[236:239], v[100:103]
    v_exp_f32 v212, v212
    v_mfma_f32_16x16x32_bf16 v[132:135], a[132:135], v[244:247], v[132:135]
    v_exp_f32 v213, v213
    s_waitcnt lgkmcnt(0)
    v_mfma_f32_16x16x32_bf16 v[40:43], a[136:139], v[220:223], v[40:43]
    v_exp_f32 v214, v214
    v_mfma_f32_16x16x32_bf16 v[72:75], a[136:139], v[228:231], v[72:75]
    v_exp_f32 v215, v215
    v_mfma_f32_16x16x32_bf16 v[104:107], a[136:139], v[236:239], v[104:107]
    v_cvt_pk_bf16_f32 v226, v188, v189
    v_cvt_pk_bf16_f32 v227, v190, v191
    v_mfma_f32_16x16x32_bf16 v[136:139], a[136:139], v[244:247], v[136:139]
    v_cvt_pk_bf16_f32 v234, v196, v197
    v_cvt_pk_bf16_f32 v235, v198, v199
    v_mfma_f32_16x16x32_bf16 v[44:47], a[140:143], v[220:223], v[44:47]
    v_cvt_pk_bf16_f32 v242, v204, v205
    v_cvt_pk_bf16_f32 v243, v206, v207
    v_mfma_f32_16x16x32_bf16 v[76:79], a[140:143], v[228:231], v[76:79]
    v_cvt_pk_bf16_f32 v250, v212, v213
    v_cvt_pk_bf16_f32 v251, v214, v215
    v_mfma_f32_16x16x32_bf16 v[108:111], a[140:143], v[236:239], v[108:111]
    v_add_u32 v2, s34, v2
    v_mfma_f32_16x16x32_bf16 v[140:143], a[140:143], v[244:247], v[140:143]
    s_cmp_lt_u32 s31, 6
    s_cbranch_scc1 L_loop
    s_waitcnt vmcnt(8) lgkmcnt(0)
    s_barrier
    v_mfma_f32_16x16x32_bf16 v[176:179], a[80:83], a[0:3], -4.0
    s_lshl_b32 s90, s30, 13
    v_mfma_f32_16x16x32_bf16 v[176:179], a[84:87], a[4:7], v[176:179]
    ds_read_b64_tr_b16 a[112:113], v3 offset:0
    ds_read_b64_tr_b16 a[114:115], v3 offset:4096
    v_mfma_f32_16x16x32_bf16 v[176:179], a[88:91], a[8:11], v[176:179]
    ds_read_b64_tr_b16 a[116:117], v3 offset:8
    ds_read_b64_tr_b16 a[168:169], v4 offset:0
    v_mfma_f32_16x16x32_bf16 v[176:179], a[92:95], a[12:15], v[176:179]
    ds_read_b64_tr_b16 a[118:119], v3 offset:4104
    ds_read_b64_tr_b16 a[120:121], v3 offset:256
    ds_read_b64_tr_b16 a[122:123], v3 offset:4352
    v_mfma_f32_16x16x32_bf16 v[184:187], a[80:83], a[16:19], -4.0
    ds_read_b64_tr_b16 a[170:171], v4 offset:4096
    ds_read_b64_tr_b16 a[172:173], v4 offset:8
    v_mfma_f32_16x16x32_bf16 v[184:187], a[84:87], a[20:23], v[184:187]
    ds_read_b64_tr_b16 a[174:175], v4 offset:4104
    ds_read_b64_tr_b16 a[176:177], v4 offset:256
    v_mfma_f32_16x16x32_bf16 v[184:187], a[88:91], a[24:27], v[184:187]
    v_lshrrev_b32 v252, 4, v0
    ds_read_b64_tr_b16 a[124:125], v3 offset:264
    ds_read_b64_tr_b16 a[126:127], v3 offset:4360
    v_mfma_f32_16x16x32_bf16 v[184:187], a[92:95], a[28:31], v[184:187]
    ds_read_b64_tr_b16 a[178:179], v4 offset:4352
    v_exp_f32 v176, v176
    v_mfma_f32_16x16x32_bf16 v[180:183], a[96:99], a[0:3], -4.0
    ds_read_b128 a[200:203], v1 offset:0
    ds_read_b128 a[204:207], v1 offset:256
    v_mfma_f32_16x16x32_bf16 v[180:183], a[100:103], a[4:7], v[180:183]
    ds_read_b64_tr_b16 a[128:129], v3 offset:512
    v_exp_f32 v177, v177
    v_mfma_f32_16x16x32_bf16 v[180:183], a[104:107], a[8:11], v[180:183]
    v_subrev_u32 v5, s40, v2
    s_mul_i32 s42, s30, 9216
    v_mfma_f32_16x16x32_bf16 v[180:183], a[108:111], a[12:15], v[180:183]
    ds_read_b64_tr_b16 a[130:131], v3 offset:4608
    v_mfma_f32_16x16x32_bf16 v[188:191], a[96:99], a[16:19], -4.0
    v_exp_f32 v178, v178
    v_mfma_f32_16x16x32_bf16 v[188:191], a[100:103], a[20:23], v[188:191]
    ds_read_b64_tr_b16 a[132:133], v3 offset:520
    ds_read_b128 a[208:211], v1 offset:512
    v_mfma_f32_16x16x32_bf16 v[188:191], a[104:107], a[24:27], v[188:191]
    ds_read_b64_tr_b16 a[134:135], v3 offset:4616
    s_waitcnt lgkmcnt(5)
    v_mfma_f32_16x16x32_bf16 v[188:191], a[108:111], a[28:31], v[188:191]
    ds_read_b64_tr_b16 a[136:137], v3 offset:768
    v_and_b32 v255, 15, v0
    v_mfma_f32_16x16x32_bf16 a[144:147], a[164:167], v[216:219], a[144:147]
    ds_read_b64_tr_b16 a[138:139], v3 offset:4864
    ds_read_b64_tr_b16 a[140:141], v3 offset:776
    v_mfma_f32_16x16x32_bf16 a[148:151], a[164:167], v[224:227], a[148:151]
    ds_read_b64_tr_b16 a[142:143], v3 offset:4872
    v_and_b32 v6, 7, v0
    v_mfma_f32_16x16x32_bf16 v[16:19], a[112:115], v[216:219], v[16:19]
    ds_read_b128 a[212:215], v1 offset:768
    v_exp_f32 v179, v179
    v_mfma_f32_16x16x32_bf16 v[48:51], a[112:115], v[224:227], v[48:51]
    ds_read_b128 a[216:219], v1 offset:4096
    ds_read_b128 a[220:223], v1 offset:4352
    v_mfma_f32_16x16x32_bf16 v[20:23], a[116:119], v[216:219], v[20:23]
    ds_read_b64_tr_b16 a[180:181], v4 offset:264
    v_mfma_f32_16x16x32_bf16 v[52:55], a[116:119], v[224:227], v[52:55]
    v_exp_f32 v180, v180
    v_mfma_f32_16x16x32_bf16 v[24:27], a[120:123], v[216:219], v[24:27]
    v_exp_f32 v181, v181
    v_mfma_f32_16x16x32_bf16 v[56:59], a[120:123], v[224:227], v[56:59]
    ds_read_b128 a[224:227], v1 offset:4608
    v_cvt_pk_bf16_f32 v220, v176, v177
    v_mfma_f32_16x16x32_bf16 v[28:31], a[124:127], v[216:219], v[28:31]
    v_exp_f32 v184, v184
    s_waitcnt lgkmcnt(4)
    v_mfma_f32_16x16x32_bf16 v[60:63], a[124:127], v[224:227], v[60:63]
    ds_read_b64_tr_b16 a[182:183], v4 offset:4360
    v_exp_f32 v188, v188
    v_mfma_f32_16x16x32_bf16 v[32:35], a[128:131], v[216:219], v[32:35]
    ds_read_b128 a[228:231], v1 offset:4864
    ds_read_b64_tr_b16 a[184:185], v4 offset:512
    v_mfma_f32_16x16x32_bf16 v[64:67], a[128:131], v[224:227], v[64:67]
    ds_read_b64_tr_b16 a[186:187], v4 offset:4608
    v_mfma_f32_16x16x32_bf16 v[36:39], a[132:135], v[216:219], v[36:39]
    v_xor_b32 v6, v6, v252
    v_mfma_f32_16x16x32_bf16 v[68:71], a[132:135], v[224:227], v[68:71]
    ds_read_b64_tr_b16 a[188:189], v4 offset:520
    v_lshlrev_b32 v6, 4, v6
    v_mfma_f32_16x16x32_bf16 v[40:43], a[136:139], v[216:219], v[40:43]
    v_exp_f32 v185, v185
    v_mfma_f32_16x16x32_bf16 v[72:75], a[136:139], v[224:227], v[72:75]
    ds_read_b64_tr_b16 a[190:191], v4 offset:4616
    v_lshl_add_u32 v6, v255, 8, v6
    v_mfma_f32_16x16x32_bf16 v[44:47], a[140:143], v[216:219], v[44:47]
    v_exp_f32 v186, v186
    v_mfma_f32_16x16x32_bf16 v[76:79], a[140:143], v[224:227], v[76:79]
    s_add_u32 s42, s42, 98304
    v_lshl_add_u32 v10, v0, 4, s42
    v_mfma_f32_16x16x32_bf16 v[192:195], a[200:203], a[0:3], -4.0
    v_exp_f32 v187, v187
    v_mfma_f32_16x16x32_bf16 v[192:195], a[204:207], a[4:7], v[192:195]
    v_exp_f32 v182, v182
    v_mfma_f32_16x16x32_bf16 v[192:195], a[208:211], a[8:11], v[192:195]
    ds_read_b64_tr_b16 a[192:193], v4 offset:768
    s_waitcnt lgkmcnt(2)
    v_mfma_f32_16x16x32_bf16 v[192:195], a[212:215], a[12:15], v[192:195]
    v_cvt_pk_bf16_f32 v221, v178, v179
    v_mfma_f32_16x16x32_bf16 v[200:203], a[200:203], a[16:19], -4.0
    ds_read_b64_tr_b16 a[194:195], v4 offset:4864
    v_exp_f32 v189, v189
    v_mfma_f32_16x16x32_bf16 v[200:203], a[204:207], a[20:23], v[200:203]
    v_cvt_pk_bf16_f32 v228, v184, v185
    v_mfma_f32_16x16x32_bf16 v[200:203], a[208:211], a[24:27], v[200:203]
    ds_read_b128 a[200:203], v2 offset:0
    v_cvt_pk_bf16_f32 v229, v186, v187
    v_mfma_f32_16x16x32_bf16 v[200:203], a[212:215], a[28:31], v[200:203]
    v_exp_f32 v183, v183
    v_exp_f32 v190, v190
    v_mfma_f32_16x16x32_bf16 v[196:199], a[216:219], a[0:3], -4.0
    v_exp_f32 v191, v191
    v_mfma_f32_16x16x32_bf16 v[196:199], a[220:223], a[4:7], v[196:199]
    ds_read_b128 a[204:207], v2 offset:256
    v_add_u32 v6, s90, v6
    v_mfma_f32_16x16x32_bf16 v[196:199], a[224:227], a[8:11], v[196:199]
    v_cvt_pk_bf16_f32 v222, v180, v181
    v_mfma_f32_16x16x32_bf16 v[196:199], a[228:231], a[12:15], v[196:199]
    v_cvt_pk_bf16_f32 v223, v182, v183
    v_cvt_pk_bf16_f32 v230, v188, v189
    v_mfma_f32_16x16x32_bf16 v[204:207], a[216:219], a[16:19], -4.0
    ds_read_b64_tr_b16 a[196:197], v4 offset:776
    ds_read_b128 a[208:211], v2 offset:512
    v_mfma_f32_16x16x32_bf16 v[204:207], a[220:223], a[20:23], v[204:207]
    v_xor_b32 v7, 64, v6
    v_xor_b32 v8, v255, v252
    v_mfma_f32_16x16x32_bf16 v[204:207], a[224:227], a[24:27], v[204:207]
    v_cvt_pk_bf16_f32 v231, v190, v191
    v_exp_f32 v200, v200
    v_mfma_f32_16x16x32_bf16 v[204:207], a[228:231], a[28:31], v[204:207]
    v_exp_f32 v196, v196
    v_mfma_f32_16x16x32_bf16 a[144:147], a[164:167], v[220:223], a[144:147]
    ds_read_b64_tr_b16 a[198:199], v4 offset:4872
    v_mfma_f32_16x16x32_bf16 a[148:151], a[164:167], v[228:231], a[148:151]
    ds_read_b128 a[212:215], v2 offset:768
    v_exp_f32 v197, v197
    v_mfma_f32_16x16x32_bf16 v[16:19], a[168:171], v[220:223], v[16:19]
    v_exp_f32 v198, v198
    v_mfma_f32_16x16x32_bf16 v[48:51], a[168:171], v[228:231], v[48:51]
    v_lshlrev_b32 v8, 4, v8
    v_lshl_add_u32 v8, v252, 8, v8
    v_mfma_f32_16x16x32_bf16 v[20:23], a[172:175], v[220:223], v[20:23]
    v_exp_f32 v192, v192
    v_mfma_f32_16x16x32_bf16 v[52:55], a[172:175], v[228:231], v[52:55]
    v_exp_f32 v204, v204
    v_mfma_f32_16x16x32_bf16 v[24:27], a[176:179], v[220:223], v[24:27]
    v_add_u32 v8, s90, v8
    s_waitcnt lgkmcnt(1)
    v_mfma_f32_16x16x32_bf16 v[56:59], a[176:179], v[228:231], v[56:59]
    s_xor_b32 s43, s30, 1
    s_mul_i32 s43, s43, 9216
    v_xor_b32 v252, 64, v8
    v_mfma_f32_16x16x32_bf16 v[28:31], a[180:183], v[220:223], v[28:31]
    v_exp_f32 v193, v193
    v_mfma_f32_16x16x32_bf16 v[60:63], a[180:183], v[228:231], v[60:63]
    ds_read_b128 a[216:219], v2 offset:4096
    v_mfma_f32_16x16x32_bf16 v[32:35], a[184:187], v[220:223], v[32:35]
    v_exp_f32 v205, v205
    v_mfma_f32_16x16x32_bf16 v[64:67], a[184:187], v[228:231], v[64:67]
    v_exp_f32 v199, v199
    v_exp_f32 v206, v206
    v_mfma_f32_16x16x32_bf16 v[36:39], a[188:191], v[220:223], v[36:39]
    ds_read_b128 a[220:223], v2 offset:4352
    s_add_u32 s43, s43, 98304
    v_mfma_f32_16x16x32_bf16 v[68:71], a[188:191], v[228:231], v[68:71]
    v_exp_f32 v194, v194
    v_mfma_f32_16x16x32_bf16 v[40:43], a[192:195], v[220:223], v[40:43]
    v_cvt_pk_bf16_f32 v218, v196, v197
    v_exp_f32 v201, v201
    v_mfma_f32_16x16x32_bf16 v[72:75], a[192:195], v[228:231], v[72:75]
    v_exp_f32 v202, v202
    s_waitcnt lgkmcnt(1)
    v_mfma_f32_16x16x32_bf16 v[44:47], a[196:199], v[220:223], v[44:47]
    ds_read_b128 a[224:227], v2 offset:4608
    v_lshl_add_u32 v11, v0, 4, s43
    v_mfma_f32_16x16x32_bf16 v[76:79], a[196:199], v[228:231], v[76:79]
    ds_read_b128 a[228:231], v2 offset:4864
    v_exp_f32 v195, v195
    v_mfma_f32_16x16x32_bf16 v[176:179], a[200:203], a[0:3], -4.0
    v_exp_f32 v203, v203
    v_mfma_f32_16x16x32_bf16 v[176:179], a[204:207], a[4:7], v[176:179]
    v_lshlrev_b32 v255, 4, v0
    v_cvt_pk_bf16_f32 v216, v192, v193
    v_cvt_pk_bf16_f32 v217, v194, v195
    v_mfma_f32_16x16x32_bf16 v[176:179], a[208:211], a[8:11], v[176:179]
    v_exp_f32 v207, v207
    v_mfma_f32_16x16x32_bf16 v[176:179], a[212:215], a[12:15], v[176:179]
    v_mov_b32 v253, s55
    v_cvt_pk_bf16_f32 v219, v198, v199
    v_mfma_f32_16x16x32_bf16 v[184:187], a[200:203], a[16:19], -4.0
    v_cvt_pk_bf16_f32 v226, v204, v205
    v_mfma_f32_16x16x32_bf16 v[184:187], a[204:207], a[20:23], v[184:187]
    v_exp_f32 v176, v176
    v_exp_f32 v177, v177
    v_mfma_f32_16x16x32_bf16 v[184:187], a[208:211], a[24:27], v[184:187]
    v_cvt_pk_bf16_f32 v224, v200, v201
    v_exp_f32 v178, v178
    v_mfma_f32_16x16x32_bf16 v[184:187], a[212:215], a[28:31], v[184:187]
    v_cvt_pk_bf16_f32 v225, v202, v203
    v_cvt_pk_bf16_f32 v227, v206, v207
    s_waitcnt lgkmcnt(0)
    v_mfma_f32_16x16x32_bf16 v[180:183], a[216:219], a[0:3], -4.0
    v_exp_f32 v179, v179
    v_cvt_pk_bf16_f32 v220, v176, v177
    v_cvt_pk_bf16_f32 v221, v178, v179
    v_mfma_f32_16x16x32_bf16 v[180:183], a[220:223], a[4:7], v[180:183]
    v_exp_f32 v184, v184
    v_exp_f32 v185, v185
    v_exp_f32 v186, v186
    v_mfma_f32_16x16x32_bf16 v[180:183], a[224:227], a[8:11], v[180:183]
    s_waitcnt vmcnt(0)
    s_barrier
    v_mfma_f32_16x16x32_bf16 v[180:183], a[228:231], a[12:15], v[180:183]
    ds_read_b64_tr_b16 a[0:1], v3 offset:32768
    ds_read_b64_tr_b16 a[2:3], v3 offset:36864
    v_mfma_f32_16x16x32_bf16 v[188:191], a[216:219], a[16:19], -4.0
    ds_read_b64_tr_b16 a[4:5], v3 offset:32776
    ds_read_b64_tr_b16 a[6:7], v3 offset:36872
    v_mfma_f32_16x16x32_bf16 v[188:191], a[220:223], a[20:23], v[188:191]
    ds_read_b64_tr_b16 a[8:9], v3 offset:33024
    v_exp_f32 v180, v180
    v_mfma_f32_16x16x32_bf16 v[188:191], a[224:227], a[24:27], v[188:191]
    ds_read_b64_tr_b16 a[10:11], v3 offset:37120
    v_exp_f32 v181, v181
    v_mfma_f32_16x16x32_bf16 v[188:191], a[228:231], a[28:31], v[188:191]
    ds_read_b64_tr_b16 a[12:13], v3 offset:33032
    ds_read_b64_tr_b16 a[14:15], v3 offset:37128
    v_mfma_f32_16x16x32_bf16 a[144:147], a[164:167], v[216:219], a[144:147]
    ds_read_b64_tr_b16 a[16:17], v3 offset:33280
    ds_read_b64_tr_b16 a[18:19], v3 offset:37376
    v_mfma_f32_16x16x32_bf16 a[148:151], a[164:167], v[224:227], a[148:151]
    ds_read_b64_tr_b16 a[20:21], v3 offset:33288
    s_waitcnt lgkmcnt(9)
    v_mfma_f32_16x16x32_bf16 v[16:19], a[0:3], v[216:219], v[16:19]
    ds_read_b64_tr_b16 a[22:23], v3 offset:37384
    ds_read_b64_tr_b16 a[24:25], v3 offset:33536
    v_mfma_f32_16x16x32_bf16 v[48:51], a[0:3], v[224:227], v[48:51]
    ds_read_b64_tr_b16 a[26:27], v3 offset:37632
    s_waitcnt lgkmcnt(9)
    v_mfma_f32_16x16x32_bf16 v[20:23], a[4:7], v[216:219], v[20:23]
    ds_read_b64_tr_b16 a[28:29], v3 offset:33544
    ds_read_b64_tr_b16 a[0:1], v4 offset:32768
    v_mfma_f32_16x16x32_bf16 v[52:55], a[4:7], v[224:227], v[52:55]
    ds_read_b64_tr_b16 a[30:31], v3 offset:37640
    s_waitcnt lgkmcnt(9)
    v_mfma_f32_16x16x32_bf16 v[24:27], a[8:11], v[216:219], v[24:27]
    ds_read_b64_tr_b16 a[2:3], v4 offset:36864
    v_exp_f32 v187, v187
    v_mfma_f32_16x16x32_bf16 v[56:59], a[8:11], v[224:227], v[56:59]
    v_exp_f32 v182, v182
    v_mfma_f32_16x16x32_bf16 v[28:31], a[12:15], v[216:219], v[28:31]
    ds_read_b64_tr_b16 a[4:5], v4 offset:32776
    s_waitcnt lgkmcnt(5)
    v_mfma_f32_16x16x32_bf16 v[60:63], a[12:15], v[224:227], v[60:63]
    ds_read_b64_tr_b16 a[6:7], v4 offset:36872
    ds_read_b64_tr_b16 a[8:9], v4 offset:33024
    v_mfma_f32_16x16x32_bf16 v[32:35], a[16:19], v[216:219], v[32:35]
    ds_read_b64_tr_b16 a[10:11], v4 offset:37120
    v_exp_f32 v188, v188
    v_mfma_f32_16x16x32_bf16 v[64:67], a[16:19], v[224:227], v[64:67]
    ds_read_b64_tr_b16 a[12:13], v4 offset:33032
    v_exp_f32 v183, v183
    v_mfma_f32_16x16x32_bf16 v[36:39], a[20:23], v[216:219], v[36:39]
    ds_read_b64_tr_b16 a[14:15], v4 offset:37128
    ds_read_b64_tr_b16 a[16:17], v4 offset:33280
    v_mfma_f32_16x16x32_bf16 v[68:71], a[20:23], v[224:227], v[68:71]
    ds_read_b64_tr_b16 a[18:19], v4 offset:37376
    v_exp_f32 v189, v189
    v_mfma_f32_16x16x32_bf16 v[40:43], a[24:27], v[216:219], v[40:43]
    ds_read_b64_tr_b16 a[20:21], v4 offset:33288
    s_waitcnt lgkmcnt(8)
    v_mfma_f32_16x16x32_bf16 v[72:75], a[24:27], v[224:227], v[72:75]
    v_cvt_pk_bf16_f32 v222, v180, v181
    v_cvt_pk_bf16_f32 v223, v182, v183
    v_mfma_f32_16x16x32_bf16 v[44:47], a[28:31], v[216:219], v[44:47]
    ds_read_b64_tr_b16 a[22:23], v4 offset:37384
    s_waitcnt lgkmcnt(6)
    v_mfma_f32_16x16x32_bf16 v[76:79], a[28:31], v[224:227], v[76:79]
    ds_read_b64_tr_b16 a[24:25], v4 offset:33536
    ds_read_b64_tr_b16 a[26:27], v4 offset:37632
    v_mfma_f32_16x16x32_bf16 a[144:147], a[164:167], v[220:223], a[144:147]
    v_exp_f32 v190, v190
    v_mfma_f32_16x16x32_bf16 v[16:19], a[0:3], v[220:223], v[16:19]
    ds_read_b64_tr_b16 a[28:29], v4 offset:33544
    v_exp_f32 v191, v191
    v_mfma_f32_16x16x32_bf16 v[20:23], a[4:7], v[220:223], v[20:23]
    ds_read_b64_tr_b16 a[30:31], v4 offset:37640
    s_waitcnt lgkmcnt(5)
    v_mfma_f32_16x16x32_bf16 v[24:27], a[8:11], v[220:223], v[24:27]
    v_accvgpr_read_b32 v216, a144
    s_waitcnt lgkmcnt(4)
    v_mfma_f32_16x16x32_bf16 v[28:31], a[12:15], v[220:223], v[28:31]
    v_cvt_pk_bf16_f32 v228, v184, v185
    v_accvgpr_read_b32 v217, a145
    v_mfma_f32_16x16x32_bf16 v[32:35], a[16:19], v[220:223], v[32:35]
    v_add_f32 v216, v216, v217
    s_waitcnt lgkmcnt(2)
    v_mfma_f32_16x16x32_bf16 v[36:39], a[20:23], v[220:223], v[36:39]
    v_cvt_pk_bf16_f32 v230, v188, v189
    v_cvt_pk_bf16_f32 v231, v190, v191
    v_mfma_f32_16x16x32_bf16 v[40:43], a[24:27], v[220:223], v[40:43]
    v_cvt_pk_bf16_f32 v229, v186, v187
    s_waitcnt lgkmcnt(0)
    v_mfma_f32_16x16x32_bf16 v[44:47], a[28:31], v[220:223], v[44:47]
    v_med3_f32 v217, v216, s54, v253
    v_cmp_neq_f32 s[80:81], v217, v216
    v_mfma_f32_16x16x32_bf16 a[148:151], a[164:167], v[228:231], a[148:151]
    v_rcp_f32 v216, v216
    s_or_b64 s[50:51], s[50:51], s[80:81]
    v_mfma_f32_16x16x32_bf16 v[48:51], a[0:3], v[228:231], v[48:51]
    v_pk_mul_f32 v[16:17], v[16:17], v[216:217] op_sel_hi:[1,0]
    v_pk_mul_f32 v[18:19], v[18:19], v[216:217] op_sel_hi:[1,0]
    v_pk_mul_f32 v[20:21], v[20:21], v[216:217] op_sel_hi:[1,0]
    v_pk_mul_f32 v[22:23], v[22:23], v[216:217] op_sel_hi:[1,0]
    v_pk_mul_f32 v[24:25], v[24:25], v[216:217] op_sel_hi:[1,0]
    v_pk_mul_f32 v[26:27], v[26:27], v[216:217] op_sel_hi:[1,0]
    v_pk_mul_f32 v[28:29], v[28:29], v[216:217] op_sel_hi:[1,0]
    v_pk_mul_f32 v[30:31], v[30:31], v[216:217] op_sel_hi:[1,0]
    v_mfma_f32_16x16x32_bf16 v[52:55], a[4:7], v[228:231], v[52:55]
    v_cvt_pk_bf16_f32 v16, v16, v17
    v_cvt_pk_bf16_f32 v17, v18, v19
    v_mfma_f32_16x16x32_bf16 v[56:59], a[8:11], v[228:231], v[56:59]
    v_cvt_pk_bf16_f32 v18, v20, v21
    v_cvt_pk_bf16_f32 v19, v22, v23
    v_mfma_f32_16x16x32_bf16 v[60:63], a[12:15], v[228:231], v[60:63]
    ds_write_b128 v6, v[16:19] offset:0
    v_mfma_f32_16x16x32_bf16 v[64:67], a[16:19], v[228:231], v[64:67]
    v_cvt_pk_bf16_f32 v24, v24, v25
    v_cvt_pk_bf16_f32 v25, v26, v27
    v_mfma_f32_16x16x32_bf16 v[68:71], a[20:23], v[228:231], v[68:71]
    v_cvt_pk_bf16_f32 v26, v28, v29
    v_cvt_pk_bf16_f32 v27, v30, v31
    v_mfma_f32_16x16x32_bf16 v[72:75], a[24:27], v[228:231], v[72:75]
    ds_write_b128 v7, v[24:27] offset:0
    v_mfma_f32_16x16x32_bf16 v[76:79], a[28:31], v[228:231], v[76:79]
    v_pk_mul_f32 v[32:33], v[32:33], v[216:217] op_sel_hi:[1,0]
    v_pk_mul_f32 v[34:35], v[34:35], v[216:217] op_sel_hi:[1,0]
    v_pk_mul_f32 v[36:37], v[36:37], v[216:217] op_sel_hi:[1,0]
    v_pk_mul_f32 v[38:39], v[38:39], v[216:217] op_sel_hi:[1,0]
    v_pk_mul_f32 v[40:41], v[40:41], v[216:217] op_sel_hi:[1,0]
    v_pk_mul_f32 v[42:43], v[42:43], v[216:217] op_sel_hi:[1,0]
    v_pk_mul_f32 v[44:45], v[44:45], v[216:217] op_sel_hi:[1,0]
    v_pk_mul_f32 v[46:47], v[46:47], v[216:217] op_sel_hi:[1,0]
    v_mfma_f32_16x16x32_bf16 v[192:195], a[80:83], a[32:35], -4.0
    v_cvt_pk_bf16_f32 v32, v32, v33
    v_cvt_pk_bf16_f32 v33, v34, v35
    v_mfma_f32_16x16x32_bf16 v[192:195], a[84:87], a[36:39], v[192:195]
    v_cvt_pk_bf16_f32 v34, v36, v37
    v_cvt_pk_bf16_f32 v35, v38, v39
    v_mfma_f32_16x16x32_bf16 v[192:195], a[88:91], a[40:43], v[192:195]
    ds_write_b128 v6, v[32:35] offset:128
    v_mfma_f32_16x16x32_bf16 v[192:195], a[92:95], a[44:47], v[192:195]
    v_cvt_pk_bf16_f32 v40, v40, v41
    v_cvt_pk_bf16_f32 v41, v42, v43
    v_mfma_f32_16x16x32_bf16 v[196:199], a[96:99], a[32:35], -4.0
    v_cvt_pk_bf16_f32 v42, v44, v45
    v_cvt_pk_bf16_f32 v43, v46, v47
    v_mfma_f32_16x16x32_bf16 v[196:199], a[100:103], a[36:39], v[196:199]
    ds_write_b128 v7, v[40:43] offset:128
    v_mfma_f32_16x16x32_bf16 v[196:199], a[104:107], a[40:43], v[196:199]
    v_accvgpr_read_b32 v224, a148
    v_mfma_f32_16x16x32_bf16 v[196:199], a[108:111], a[44:47], v[196:199]
    ds_read_b128 v[20:23], v8 offset:0
    ds_read_b128 v[28:31], v252 offset:1024
    v_mfma_f32_16x16x32_bf16 a[160:163], a[164:167], v[248:251], a[160:163]
    ds_read_b128 v[36:39], v8 offset:2048
    ds_read_b128 v[44:47], v252 offset:3072
    v_mfma_f32_16x16x32_bf16 a[152:155], a[164:167], v[232:235], a[152:155]
    ds_read_b128 a[80:83], v1 offset:0
    v_accvgpr_read_b32 v225, a149
    v_mfma_f32_16x16x32_bf16 a[156:159], a[164:167], v[240:243], a[156:159]
    v_add_f32 v224, v224, v225
    v_med3_f32 v225, v224, s54, v253
    v_mfma_f32_16x16x32_bf16 v[144:147], a[112:115], v[248:251], v[144:147]
    v_exp_f32 v192, v192
    v_mfma_f32_16x16x32_bf16 v[80:83], a[112:115], v[232:235], v[80:83]
    s_waitcnt lgkmcnt(4)
    buffer_store_dwordx4 v[20:23], v255, s[24:27], s96 offen offset:0 sc0 sc1
    v_mfma_f32_16x16x32_bf16 v[112:115], a[112:115], v[240:243], v[112:115]
    v_exp_f32 v193, v193
    v_mfma_f32_16x16x32_bf16 v[148:151], a[116:119], v[248:251], v[148:151]
    ds_read_b64_tr_b16 a[112:113], v3 offset:32768
    v_cmp_neq_f32 s[82:83], v225, v224
    v_mfma_f32_16x16x32_bf16 v[84:87], a[116:119], v[232:235], v[84:87]
    ds_read_b128 a[84:87], v1 offset:256
    ds_read_b64_tr_b16 a[114:115], v3 offset:36864
    v_mfma_f32_16x16x32_bf16 v[116:119], a[116:119], v[240:243], v[116:119]
    v_exp_f32 v196, v196
    v_mfma_f32_16x16x32_bf16 v[152:155], a[120:123], v[248:251], v[152:155]
    ds_read_b128 a[88:91], v1 offset:512
    v_rcp_f32 v224, v224
    s_or_b64 s[50:51], s[50:51], s[82:83]
    v_mfma_f32_16x16x32_bf16 v[88:91], a[120:123], v[232:235], v[88:91]
    ds_read_b128 a[92:95], v1 offset:768
    v_pk_mul_f32 v[48:49], v[48:49], v[224:225] op_sel_hi:[1,0]
    v_pk_mul_f32 v[50:51], v[50:51], v[224:225] op_sel_hi:[1,0]
    v_pk_mul_f32 v[52:53], v[52:53], v[224:225] op_sel_hi:[1,0]
    v_pk_mul_f32 v[54:55], v[54:55], v[224:225] op_sel_hi:[1,0]
    v_pk_mul_f32 v[56:57], v[56:57], v[224:225] op_sel_hi:[1,0]
    v_pk_mul_f32 v[58:59], v[58:59], v[224:225] op_sel_hi:[1,0]
    v_pk_mul_f32 v[60:61], v[60:61], v[224:225] op_sel_hi:[1,0]
    v_pk_mul_f32 v[62:63], v[62:63], v[224:225] op_sel_hi:[1,0]
    v_mfma_f32_16x16x32_bf16 v[120:123], a[120:123], v[240:243], v[120:123]
    s_waitcnt lgkmcnt(5)
    buffer_store_dwordx4 v[28:31], v255, s[24:27], s96 offen offset:1024 sc0 sc1
    v_mfma_f32_16x16x32_bf16 v[156:159], a[124:127], v[248:251], v[156:159]
    ds_read_b128 a[96:99], v1 offset:4096
    ds_read_b64_tr_b16 a[116:117], v3 offset:32776
    v_mfma_f32_16x16x32_bf16 v[92:95], a[124:127], v[232:235], v[92:95]
    v_cvt_pk_bf16_f32 v48, v48, v49
    v_cvt_pk_bf16_f32 v49, v50, v51
    v_mfma_f32_16x16x32_bf16 v[124:127], a[124:127], v[240:243], v[124:127]
    ds_read_b64_tr_b16 a[118:119], v3 offset:36872
    v_cvt_pk_bf16_f32 v50, v52, v53
    v_mfma_f32_16x16x32_bf16 v[160:163], a[128:131], v[248:251], v[160:163]
    ds_read_b64_tr_b16 a[120:121], v3 offset:33024
    v_cvt_pk_bf16_f32 v51, v54, v55
    v_mfma_f32_16x16x32_bf16 v[96:99], a[128:131], v[232:235], v[96:99]
    ds_write_b128 v6, v[48:51] offset:4096
    v_cvt_pk_bf16_f32 v56, v56, v57
    v_cvt_pk_bf16_f32 v57, v58, v59
    v_mfma_f32_16x16x32_bf16 v[128:131], a[128:131], v[240:243], v[128:131]
    v_cvt_pk_bf16_f32 v58, v60, v61
    v_cvt_pk_bf16_f32 v59, v62, v63
    v_mfma_f32_16x16x32_bf16 v[164:167], a[132:135], v[248:251], v[164:167]
    ds_read_b128 a[100:103], v1 offset:4352
    ds_write_b128 v7, v[56:59] offset:4096
    v_mfma_f32_16x16x32_bf16 v[100:103], a[132:135], v[232:235], v[100:103]
    v_pk_mul_f32 v[64:65], v[64:65], v[224:225] op_sel_hi:[1,0]
    v_pk_mul_f32 v[66:67], v[66:67], v[224:225] op_sel_hi:[1,0]
    v_pk_mul_f32 v[68:69], v[68:69], v[224:225] op_sel_hi:[1,0]
    v_pk_mul_f32 v[70:71], v[70:71], v[224:225] op_sel_hi:[1,0]
    v_pk_mul_f32 v[72:73], v[72:73], v[224:225] op_sel_hi:[1,0]
    v_pk_mul_f32 v[74:75], v[74:75], v[224:225] op_sel_hi:[1,0]
    v_pk_mul_f32 v[76:77], v[76:77], v[224:225] op_sel_hi:[1,0]
    v_pk_mul_f32 v[78:79], v[78:79], v[224:225] op_sel_hi:[1,0]
    v_mfma_f32_16x16x32_bf16 v[132:135], a[132:135], v[240:243], v[132:135]
    v_exp_f32 v197, v197
    v_mfma_f32_16x16x32_bf16 v[168:171], a[136:139], v[248:251], v[168:171]
    ds_read_b128 a[104:107], v1 offset:4608
    v_exp_f32 v198, v198
    v_mfma_f32_16x16x32_bf16 v[104:107], a[136:139], v[232:235], v[104:107]
    ds_read_b64_tr_b16 a[122:123], v3 offset:37120
    v_cvt_pk_bf16_f32 v64, v64, v65
    v_mfma_f32_16x16x32_bf16 v[136:139], a[136:139], v[240:243], v[136:139]
    ds_read_b64_tr_b16 a[124:125], v3 offset:33032
    s_waitcnt lgkmcnt(5)
    v_mfma_f32_16x16x32_bf16 v[172:175], a[140:143], v[248:251], v[172:175]
    v_exp_f32 v199, v199
    v_mfma_f32_16x16x32_bf16 v[108:111], a[140:143], v[232:235], v[108:111]
    ds_read_b64_tr_b16 a[126:127], v3 offset:37128
    buffer_store_dwordx4 v[36:39], v255, s[24:27], s96 offen offset:2048 sc0 sc1
    v_mfma_f32_16x16x32_bf16 v[140:143], a[140:143], v[240:243], v[140:143]
    v_cvt_pk_bf16_f32 v65, v66, v67
    v_cvt_pk_bf16_f32 v66, v68, v69
    v_mfma_f32_16x16x32_bf16 v[176:179], a[80:83], a[32:35], -4.0
    ds_read_b128 a[108:111], v1 offset:4864
    v_cvt_pk_bf16_f32 v67, v70, v71
    v_mfma_f32_16x16x32_bf16 v[176:179], a[84:87], a[36:39], v[176:179]
    ds_write_b128 v6, v[64:67] offset:4224
    v_mfma_f32_16x16x32_bf16 v[176:179], a[88:91], a[40:43], v[176:179]
    v_exp_f32 v194, v194
    v_mfma_f32_16x16x32_bf16 v[176:179], a[92:95], a[44:47], v[176:179]
    v_cvt_pk_bf16_f32 v238, v196, v197
    v_cvt_pk_bf16_f32 v72, v72, v73
    s_waitcnt lgkmcnt(2)
    v_mfma_f32_16x16x32_bf16 v[208:211], a[80:83], a[64:67], -4.0
    ds_read_b64_tr_b16 a[128:129], v3 offset:33280
    v_cvt_pk_bf16_f32 v73, v74, v75
    v_cvt_pk_bf16_f32 v74, v76, v77
    v_mfma_f32_16x16x32_bf16 v[208:211], a[84:87], a[68:71], v[208:211]
    ds_read_b64_tr_b16 a[130:131], v3 offset:37376
    v_cvt_pk_bf16_f32 v75, v78, v79
    v_mfma_f32_16x16x32_bf16 v[208:211], a[88:91], a[72:75], v[208:211]
    ds_write_b128 v7, v[72:75] offset:4224
    v_mfma_f32_16x16x32_bf16 v[208:211], a[92:95], a[76:79], v[208:211]
    ds_read_b64_tr_b16 a[132:133], v3 offset:33288
    s_waitcnt lgkmcnt(4)
    v_mfma_f32_16x16x32_bf16 v[180:183], a[96:99], a[32:35], -4.0
    buffer_store_dwordx4 v[44:47], v255, s[24:27], s96 offen offset:3072 sc0 sc1
    v_mfma_f32_16x16x32_bf16 v[180:183], a[100:103], a[36:39], v[180:183]
    v_exp_f32 v195, v195
    v_mfma_f32_16x16x32_bf16 v[180:183], a[104:107], a[40:43], v[180:183]
    ds_read_b64_tr_b16 a[134:135], v3 offset:37384
    ds_read_b64_tr_b16 a[136:137], v3 offset:33536
    v_mfma_f32_16x16x32_bf16 v[180:183], a[108:111], a[44:47], v[180:183]
    ds_read_b128 v[52:55], v8 offset:4096
    ds_read_b128 v[60:63], v252 offset:5120
    v_mfma_f32_16x16x32_bf16 v[212:215], a[96:99], a[64:67], -4.0
    ds_read_b64_tr_b16 a[138:139], v3 offset:37632
    ds_read_b128 v[68:71], v8 offset:6144
    v_mfma_f32_16x16x32_bf16 v[212:215], a[100:103], a[68:71], v[212:215]
    ds_read_b128 v[76:79], v252 offset:7168
    v_cvt_pk_bf16_f32 v239, v198, v199
    v_mfma_f32_16x16x32_bf16 v[212:215], a[104:107], a[72:75], v[212:215]
    v_cvt_pk_bf16_f32 v236, v192, v193
    v_cvt_pk_bf16_f32 v237, v194, v195
    v_mfma_f32_16x16x32_bf16 v[212:215], a[108:111], a[76:79], v[212:215]
    v_exp_f32 v180, v180
    v_mfma_f32_16x16x32_bf16 a[152:155], a[164:167], v[236:239], a[152:155]
    ds_read_b64_tr_b16 a[140:141], v3 offset:33544
    v_exp_f32 v176, v176
    v_mfma_f32_16x16x32_bf16 v[80:83], a[168:171], v[236:239], v[80:83]
    v_exp_f32 v208, v208
    v_mfma_f32_16x16x32_bf16 v[84:87], a[172:175], v[236:239], v[84:87]
    v_exp_f32 v212, v212
    v_mfma_f32_16x16x32_bf16 v[88:91], a[176:179], v[236:239], v[88:91]
    v_exp_f32 v181, v181
    v_mfma_f32_16x16x32_bf16 v[92:95], a[180:183], v[236:239], v[92:95]
    v_exp_f32 v209, v209
    v_mfma_f32_16x16x32_bf16 v[96:99], a[184:187], v[236:239], v[96:99]
    v_exp_f32 v213, v213
    v_mfma_f32_16x16x32_bf16 v[100:103], a[188:191], v[236:239], v[100:103]
    v_exp_f32 v210, v210
    v_mfma_f32_16x16x32_bf16 v[104:107], a[192:195], v[236:239], v[104:107]
    s_waitcnt lgkmcnt(0)
    buffer_store_dwordx4 v[52:55], v255, s[24:27], s97 offen offset:0 sc0 sc1
    v_mfma_f32_16x16x32_bf16 v[108:111], a[196:199], v[236:239], v[108:111]
    v_exp_f32 v214, v214
    v_mfma_f32_16x16x32_bf16 v[192:195], a[200:203], a[32:35], -4.0
    v_exp_f32 v211, v211
    v_mfma_f32_16x16x32_bf16 v[192:195], a[204:207], a[36:39], v[192:195]
    ds_read_b64_tr_b16 a[142:143], v3 offset:37640
    v_exp_f32 v177, v177
    v_mfma_f32_16x16x32_bf16 v[192:195], a[208:211], a[40:43], v[192:195]
    ds_read_b128 a[200:203], v5 offset:0
    v_mfma_f32_16x16x32_bf16 v[192:195], a[212:215], a[44:47], v[192:195]
    ds_read_b128 a[204:207], v5 offset:256
    v_exp_f32 v215, v215
    v_mfma_f32_16x16x32_bf16 v[196:199], a[216:219], a[32:35], -4.0
    v_cvt_pk_bf16_f32 v248, v208, v209
    v_cvt_pk_bf16_f32 v250, v212, v213
    v_mfma_f32_16x16x32_bf16 v[196:199], a[220:223], a[36:39], v[196:199]
    ds_read_b128 a[208:211], v5 offset:512
    v_cvt_pk_bf16_f32 v249, v210, v211
    v_mfma_f32_16x16x32_bf16 v[196:199], a[224:227], a[40:43], v[196:199]
    ds_read_b128 a[212:215], v5 offset:768
    v_cvt_pk_bf16_f32 v251, v214, v215
    v_mfma_f32_16x16x32_bf16 v[196:199], a[228:231], a[44:47], v[196:199]
    ds_read_b128 a[216:219], v5 offset:4096
    buffer_store_dwordx4 v[60:63], v255, s[24:27], s97 offen offset:1024 sc0 sc1
    v_mfma_f32_16x16x32_bf16 a[160:163], a[164:167], v[248:251], a[160:163]
    ds_read_b128 a[220:223], v5 offset:4352
    v_exp_f32 v178, v178
    v_mfma_f32_16x16x32_bf16 v[144:147], a[112:115], v[248:251], v[144:147]
    v_exp_f32 v182, v182
    v_mfma_f32_16x16x32_bf16 v[148:151], a[116:119], v[248:251], v[148:151]
    ds_read_b128 a[224:227], v5 offset:4608
    s_waitcnt lgkmcnt(5)
    v_mfma_f32_16x16x32_bf16 v[152:155], a[120:123], v[248:251], v[152:155]
    v_exp_f32 v183, v183
    v_mfma_f32_16x16x32_bf16 v[156:159], a[124:127], v[248:251], v[156:159]
    s_waitcnt lgkmcnt(3)
    buffer_store_dwordx4 v[68:71], v255, s[24:27], s97 offen offset:2048 sc0 sc1
    v_mfma_f32_16x16x32_bf16 v[160:163], a[128:131], v[248:251], v[160:163]
    buffer_store_dwordx4 v[76:79], v255, s[24:27], s97 offen offset:3072 sc0 sc1
    v_mfma_f32_16x16x32_bf16 v[164:167], a[132:135], v[248:251], v[164:167]
    v_exp_f32 v179, v179
    v_exp_f32 v196, v196
    v_mfma_f32_16x16x32_bf16 v[168:171], a[136:139], v[248:251], v[168:171]
    ds_read_b128 a[228:231], v5 offset:4864
    v_cvt_pk_bf16_f32 v232, v176, v177
    v_mfma_f32_16x16x32_bf16 v[172:175], a[140:143], v[248:251], v[172:175]
    v_exp_f32 v197, v197
    v_mfma_f32_16x16x32_bf16 v[200:203], a[200:203], a[48:51], -4.0
    v_exp_f32 v198, v198
    v_mfma_f32_16x16x32_bf16 v[200:203], a[204:207], a[52:55], v[200:203]
    v_cvt_pk_bf16_f32 v233, v178, v179
    s_nop 0
    s_cmp_lg_u32 s46, 0
    s_cbranch_scc1 L_xw0a
    ds_write_b128 v10, v[160:163] offset:0
    ds_write_b128 v10, v[164:167] offset:1024
    ds_write_b128 v10, v[168:171] offset:2048
    ds_write_b128 v10, v[172:175] offset:3072
    s_branch L_xw0b
L_xw0a:
    ds_write_b128 v10, v[144:147] offset:0
    ds_write_b128 v10, v[148:151] offset:1024
    ds_write_b128 v10, v[152:155] offset:2048
    ds_write_b128 v10, v[156:159] offset:3072
L_xw0b:
    ds_write_b32 v10, a160 offset:8192
    v_mfma_f32_16x16x32_bf16 v[200:203], a[208:211], a[56:59], v[200:203]
    v_exp_f32 v199, v199
    v_mfma_f32_16x16x32_bf16 v[200:203], a[212:215], a[60:63], v[200:203]
    v_cvt_pk_bf16_f32 v234, v180, v181
    s_waitcnt lgkmcnt(5)
    v_mfma_f32_16x16x32_bf16 v[204:207], a[216:219], a[48:51], -4.0
    v_exp_f32 v192, v192
    v_mfma_f32_16x16x32_bf16 v[204:207], a[220:223], a[52:55], v[204:207]
    v_cvt_pk_bf16_f32 v235, v182, v183
    v_exp_f32 v200, v200
    v_mfma_f32_16x16x32_bf16 v[204:207], a[224:227], a[56:59], v[204:207]
    v_exp_f32 v193, v193
    v_exp_f32 v201, v201
    v_mfma_f32_16x16x32_bf16 v[204:207], a[228:231], a[60:63], v[204:207]
    ds_read_b128 a[200:203], v2 offset:0
    v_cvt_pk_bf16_f32 v238, v196, v197
    v_mfma_f32_16x16x32_bf16 a[152:155], a[164:167], v[232:235], a[152:155]
    v_exp_f32 v194, v194
    v_mfma_f32_16x16x32_bf16 v[80:83], a[112:115], v[232:235], v[80:83]
    s_waitcnt lgkmcnt(1)
    s_barrier
    ds_read_b32 v209, v11 offset:8192
    v_mfma_f32_16x16x32_bf16 v[84:87], a[116:119], v[232:235], v[84:87]
    v_exp_f32 v195, v195
    v_mfma_f32_16x16x32_bf16 v[88:91], a[120:123], v[232:235], v[88:91]
    s_cmp_lg_u32 s46, 0
    s_cbranch_scc1 L_xr0a
    ds_read_b128 v[160:163], v11 offset:0
    ds_read_b128 v[164:167], v11 offset:1024
    ds_read_b128 v[168:171], v11 offset:2048
    ds_read_b128 v[172:175], v11 offset:3072
    s_branch L_xr0b
L_xr0a:
    ds_read_b128 v[144:147], v11 offset:0
    ds_read_b128 v[148:151], v11 offset:1024
    ds_read_b128 v[152:155], v11 offset:2048
    ds_read_b128 v[156:159], v11 offset:3072
L_xr0b:
    v_mfma_f32_16x16x32_bf16 v[92:95], a[124:127], v[232:235], v[92:95]
    v_cvt_pk_bf16_f32 v236, v192, v193
    v_cvt_pk_bf16_f32 v237, v194, v195
    v_exp_f32 v204, v204
    v_mfma_f32_16x16x32_bf16 v[96:99], a[128:131], v[232:235], v[96:99]
    v_cvt_pk_bf16_f32 v239, v198, v199
    v_accvgpr_read_b32 v208, a160
    v_mfma_f32_16x16x32_bf16 v[100:103], a[132:135], v[232:235], v[100:103]
    v_exp_f32 v202, v202
    v_mfma_f32_16x16x32_bf16 v[104:107], a[136:139], v[232:235], v[104:107]
    ds_read_b128 a[204:207], v2 offset:256
    ds_read_b128 a[208:211], v2 offset:512
    v_mfma_f32_16x16x32_bf16 v[108:111], a[140:143], v[232:235], v[108:111]
    ds_read_b128 a[212:215], v2 offset:768
    v_exp_f32 v205, v205
    v_mfma_f32_16x16x32_bf16 a[152:155], a[164:167], v[236:239], a[152:155]
    v_exp_f32 v206, v206
    v_mfma_f32_16x16x32_bf16 v[80:83], a[0:3], v[236:239], v[80:83]
    v_exp_f32 v203, v203
    v_mfma_f32_16x16x32_bf16 v[84:87], a[4:7], v[236:239], v[84:87]
    v_exp_f32 v207, v207
    v_mfma_f32_16x16x32_bf16 v[88:91], a[8:11], v[236:239], v[88:91]
    ds_read_b128 a[216:219], v2 offset:4096
    s_waitcnt lgkmcnt(4)
    v_add_f32 v208, v208, v209
    v_accvgpr_read_b32 v232, a152
    v_mfma_f32_16x16x32_bf16 v[92:95], a[12:15], v[236:239], v[92:95]
    v_cvt_pk_bf16_f32 v246, v204, v205
    v_med3_f32 v210, v208, s54, v253
    v_mfma_f32_16x16x32_bf16 v[96:99], a[16:19], v[236:239], v[96:99]
    v_cvt_pk_bf16_f32 v244, v200, v201
    v_cmp_neq_f32 s[88:89], v210, v208
    v_mfma_f32_16x16x32_bf16 v[100:103], a[20:23], v[236:239], v[100:103]
    v_cvt_pk_bf16_f32 v245, v202, v203
    v_accvgpr_read_b32 v233, a153
    v_mfma_f32_16x16x32_bf16 v[104:107], a[24:27], v[236:239], v[104:107]
    v_add_f32 v232, v232, v233
    v_med3_f32 v233, v232, s54, v253
    v_mfma_f32_16x16x32_bf16 v[108:111], a[28:31], v[236:239], v[108:111]
    v_rcp_f32 v208, v208
    s_or_b64 s[52:53], s[52:53], s[88:89]
    v_mfma_f32_16x16x32_bf16 v[184:187], a[80:83], a[48:51], -4.0
    ds_read_b128 a[220:223], v2 offset:4352
    v_cmp_neq_f32 s[84:85], v233, v232
    v_pk_add_f32 v[144:145], v[144:145], v[160:161]
    v_pk_add_f32 v[146:147], v[146:147], v[162:163]
    v_pk_add_f32 v[148:149], v[148:149], v[164:165]
    v_pk_add_f32 v[150:151], v[150:151], v[166:167]
    v_pk_add_f32 v[152:153], v[152:153], v[168:169]
    v_pk_add_f32 v[154:155], v[154:155], v[170:171]
    v_pk_add_f32 v[156:157], v[156:157], v[172:173]
    v_pk_add_f32 v[158:159], v[158:159], v[174:175]
    v_pk_mul_f32 v[144:145], v[144:145], v[208:209] op_sel_hi:[1,0]
    v_pk_mul_f32 v[146:147], v[146:147], v[208:209] op_sel_hi:[1,0]
    v_pk_mul_f32 v[148:149], v[148:149], v[208:209] op_sel_hi:[1,0]
    v_pk_mul_f32 v[150:151], v[150:151], v[208:209] op_sel_hi:[1,0]
    v_pk_mul_f32 v[152:153], v[152:153], v[208:209] op_sel_hi:[1,0]
    v_pk_mul_f32 v[154:155], v[154:155], v[208:209] op_sel_hi:[1,0]
    v_pk_mul_f32 v[156:157], v[156:157], v[208:209] op_sel_hi:[1,0]
    v_pk_mul_f32 v[158:159], v[158:159], v[208:209] op_sel_hi:[1,0]
    v_cvt_pk_bf16_f32 v160, v144, v145
    v_cvt_pk_bf16_f32 v161, v146, v147
    v_cvt_pk_bf16_f32 v162, v148, v149
    v_cvt_pk_bf16_f32 v163, v150, v151
    v_cvt_pk_bf16_f32 v164, v152, v153
    v_cvt_pk_bf16_f32 v165, v154, v155
    v_cvt_pk_bf16_f32 v166, v156, v157
    v_cvt_pk_bf16_f32 v167, v158, v159
    s_cmp_lg_u64 s[52:53], 0
    s_cbranch_scc1 L_xskip
    buffer_store_dwordx4 v[160:163], v9, s[24:27], s100 offen offset:0 sc0 sc1
    buffer_store_dwordx4 v[164:167], v9, s[24:27], s100 offen offset:64 sc0 sc1
L_xret:
    v_mfma_f32_16x16x32_bf16 v[184:187], a[84:87], a[52:55], v[184:187]
    v_rcp_f32 v232, v232
    v_mfma_f32_16x16x32_bf16 v[184:187], a[88:91], a[56:59], v[184:187]
    ds_read_b128 a[224:227], v2 offset:4608
    v_cvt_pk_bf16_f32 v247, v206, v207
    s_waitcnt lgkmcnt(2)
    v_mfma_f32_16x16x32_bf16 v[184:187], a[92:95], a[60:63], v[184:187]
    ds_read_b128 a[228:231], v2 offset:4864
    s_or_b64 s[50:51], s[50:51], s[84:85]
    v_mfma_f32_16x16x32_bf16 v[188:191], a[96:99], a[48:51], -4.0
    v_pk_mul_f32 v[80:81], v[80:81], v[232:233] op_sel_hi:[1,0]
    v_pk_mul_f32 v[82:83], v[82:83], v[232:233] op_sel_hi:[1,0]
    v_pk_mul_f32 v[84:85], v[84:85], v[232:233] op_sel_hi:[1,0]
    v_pk_mul_f32 v[86:87], v[86:87], v[232:233] op_sel_hi:[1,0]
    v_pk_mul_f32 v[88:89], v[88:89], v[232:233] op_sel_hi:[1,0]
    v_pk_mul_f32 v[90:91], v[90:91], v[232:233] op_sel_hi:[1,0]
    v_pk_mul_f32 v[92:93], v[92:93], v[232:233] op_sel_hi:[1,0]
    v_pk_mul_f32 v[94:95], v[94:95], v[232:233] op_sel_hi:[1,0]
    v_cvt_pk_bf16_f32 v80, v80, v81
    v_cvt_pk_bf16_f32 v81, v82, v83
    v_cvt_pk_bf16_f32 v82, v84, v85
    v_cvt_pk_bf16_f32 v83, v86, v87
    ds_write_b128 v6, v[80:83] offset:0
    v_cvt_pk_bf16_f32 v88, v88, v89
    v_cvt_pk_bf16_f32 v89, v90, v91
    v_cvt_pk_bf16_f32 v90, v92, v93
    v_cvt_pk_bf16_f32 v91, v94, v95
    ds_write_b128 v7, v[88:91] offset:0
    v_pk_mul_f32 v[96:97], v[96:97], v[232:233] op_sel_hi:[1,0]
    v_pk_mul_f32 v[98:99], v[98:99], v[232:233] op_sel_hi:[1,0]
    v_pk_mul_f32 v[100:101], v[100:101], v[232:233] op_sel_hi:[1,0]
    v_pk_mul_f32 v[102:103], v[102:103], v[232:233] op_sel_hi:[1,0]
    v_pk_mul_f32 v[104:105], v[104:105], v[232:233] op_sel_hi:[1,0]
    v_pk_mul_f32 v[106:107], v[106:107], v[232:233] op_sel_hi:[1,0]
    v_pk_mul_f32 v[108:109], v[108:109], v[232:233] op_sel_hi:[1,0]
    v_pk_mul_f32 v[110:111], v[110:111], v[232:233] op_sel_hi:[1,0]
    v_cvt_pk_bf16_f32 v96, v96, v97
    v_mfma_f32_16x16x32_bf16 v[188:191], a[100:103], a[52:55], v[188:191]
    v_cvt_pk_bf16_f32 v97, v98, v99
    v_cvt_pk_bf16_f32 v98, v100, v101
    v_cvt_pk_bf16_f32 v99, v102, v103
    ds_write_b128 v6, v[96:99] offset:128
    v_mfma_f32_16x16x32_bf16 v[188:191], a[104:107], a[56:59], v[188:191]
    v_cvt_pk_bf16_f32 v104, v104, v105
    v_cvt_pk_bf16_f32 v105, v106, v107
    v_cvt_pk_bf16_f32 v106, v108, v109
    v_mfma_f32_16x16x32_bf16 v[188:191], a[108:111], a[60:63], v[188:191]
    v_cvt_pk_bf16_f32 v107, v110, v111
    ds_write_b128 v7, v[104:107] offset:128
    v_mfma_f32_16x16x32_bf16 a[156:159], a[164:167], v[244:247], a[156:159]
    v_exp_f32 v184, v184
    v_mfma_f32_16x16x32_bf16 v[112:115], a[168:171], v[244:247], v[112:115]
    ds_read_b128 v[84:87], v8 offset:0
    ds_read_b128 v[92:95], v252 offset:1024
    ds_read_b128 v[100:103], v8 offset:2048
    v_mfma_f32_16x16x32_bf16 v[116:119], a[172:175], v[244:247], v[116:119]
    ds_read_b128 v[108:111], v252 offset:3072
    v_exp_f32 v185, v185
    v_mfma_f32_16x16x32_bf16 v[120:123], a[176:179], v[244:247], v[120:123]
    v_exp_f32 v188, v188
    v_mfma_f32_16x16x32_bf16 v[124:127], a[180:183], v[244:247], v[124:127]
    v_exp_f32 v189, v189
    v_mfma_f32_16x16x32_bf16 v[128:131], a[184:187], v[244:247], v[128:131]
    s_waitcnt lgkmcnt(4)
    v_mfma_f32_16x16x32_bf16 v[132:135], a[188:191], v[244:247], v[132:135]
    s_waitcnt lgkmcnt(3)
    buffer_store_dwordx4 v[84:87], v255, s[24:27], s98 offen offset:0 sc0 sc1
    v_mfma_f32_16x16x32_bf16 v[136:139], a[192:195], v[244:247], v[136:139]
    v_exp_f32 v190, v190
    v_mfma_f32_16x16x32_bf16 v[140:143], a[196:199], v[244:247], v[140:143]
    v_exp_f32 v191, v191
    v_mfma_f32_16x16x32_bf16 v[200:203], a[200:203], a[48:51], -4.0
    v_exp_f32 v186, v186
    v_mfma_f32_16x16x32_bf16 v[200:203], a[204:207], a[52:55], v[200:203]
    v_cvt_pk_bf16_f32 v242, v188, v189
    v_cvt_pk_bf16_f32 v243, v190, v191
    v_mfma_f32_16x16x32_bf16 v[200:203], a[208:211], a[56:59], v[200:203]
    v_exp_f32 v187, v187
    v_mfma_f32_16x16x32_bf16 v[200:203], a[212:215], a[60:63], v[200:203]
    v_mfma_f32_16x16x32_bf16 v[204:207], a[216:219], a[48:51], -4.0
    v_cvt_pk_bf16_f32 v240, v184, v185
    v_cvt_pk_bf16_f32 v241, v186, v187
    v_mfma_f32_16x16x32_bf16 v[204:207], a[220:223], a[52:55], v[204:207]
    s_waitcnt lgkmcnt(0)
    buffer_store_dwordx4 v[92:95], v255, s[24:27], s98 offen offset:1024 sc0 sc1
    v_mfma_f32_16x16x32_bf16 v[204:207], a[224:227], a[56:59], v[204:207]
    v_exp_f32 v200, v200
    v_mfma_f32_16x16x32_bf16 v[204:207], a[228:231], a[60:63], v[204:207]
    v_exp_f32 v201, v201
    v_mfma_f32_16x16x32_bf16 a[156:159], a[164:167], v[240:243], a[156:159]
    v_exp_f32 v202, v202
    v_mfma_f32_16x16x32_bf16 v[112:115], a[112:115], v[240:243], v[112:115]
    v_exp_f32 v204, v204
    v_mfma_f32_16x16x32_bf16 v[116:119], a[116:119], v[240:243], v[116:119]
    v_exp_f32 v205, v205
    v_mfma_f32_16x16x32_bf16 v[120:123], a[120:123], v[240:243], v[120:123]
    v_exp_f32 v206, v206
    v_mfma_f32_16x16x32_bf16 v[124:127], a[124:127], v[240:243], v[124:127]
    v_exp_f32 v207, v207
    v_mfma_f32_16x16x32_bf16 v[128:131], a[128:131], v[240:243], v[128:131]
    v_exp_f32 v203, v203
    v_mfma_f32_16x16x32_bf16 v[132:135], a[132:135], v[240:243], v[132:135]
    v_cvt_pk_bf16_f32 v246, v204, v205
    v_cvt_pk_bf16_f32 v247, v206, v207
    v_mfma_f32_16x16x32_bf16 v[136:139], a[136:139], v[240:243], v[136:139]
    v_cvt_pk_bf16_f32 v244, v200, v201
    v_cvt_pk_bf16_f32 v245, v202, v203
    v_mfma_f32_16x16x32_bf16 v[140:143], a[140:143], v[240:243], v[140:143]
    v_mfma_f32_16x16x32_bf16 a[156:159], a[164:167], v[244:247], a[156:159]
    buffer_store_dwordx4 v[100:103], v255, s[24:27], s98 offen offset:2048 sc0 sc1
    v_mfma_f32_16x16x32_bf16 v[112:115], a[0:3], v[244:247], v[112:115]
    v_mfma_f32_16x16x32_bf16 v[116:119], a[4:7], v[244:247], v[116:119]
    buffer_store_dwordx4 v[108:111], v255, s[24:27], s98 offen offset:3072 sc0 sc1
    v_mfma_f32_16x16x32_bf16 v[120:123], a[8:11], v[244:247], v[120:123]
    v_accvgpr_read_b32 v240, a156
    v_accvgpr_read_b32 v241, a157
    v_add_f32 v240, v240, v241
    v_mfma_f32_16x16x32_bf16 v[124:127], a[12:15], v[244:247], v[124:127]
    v_med3_f32 v241, v240, s54, v253
    v_cmp_neq_f32 s[86:87], v241, v240
    v_mfma_f32_16x16x32_bf16 v[128:131], a[16:19], v[244:247], v[128:131]
    v_rcp_f32 v240, v240
    s_or_b64 s[50:51], s[50:51], s[86:87]
    v_mfma_f32_16x16x32_bf16 v[132:135], a[20:23], v[244:247], v[132:135]
    v_pk_mul_f32 v[112:113], v[112:113], v[240:241] op_sel_hi:[1,0]
    v_pk_mul_f32 v[114:115], v[114:115], v[240:241] op_sel_hi:[1,0]
    v_pk_mul_f32 v[116:117], v[116:117], v[240:241] op_sel_hi:[1,0]
    v_pk_mul_f32 v[118:119], v[118:119], v[240:241] op_sel_hi:[1,0]
    v_pk_mul_f32 v[120:121], v[120:121], v[240:241] op_sel_hi:[1,0]
    v_pk_mul_f32 v[122:123], v[122:123], v[240:241] op_sel_hi:[1,0]
    v_pk_mul_f32 v[124:125], v[124:125], v[240:241] op_sel_hi:[1,0]
    v_pk_mul_f32 v[126:127], v[126:127], v[240:241] op_sel_hi:[1,0]
    v_mfma_f32_16x16x32_bf16 v[136:139], a[24:27], v[244:247], v[136:139]
    v_cvt_pk_bf16_f32 v112, v112, v113
    v_cvt_pk_bf16_f32 v113, v114, v115
    v_mfma_f32_16x16x32_bf16 v[140:143], a[28:31], v[244:247], v[140:143]
    v_cvt_pk_bf16_f32 v114, v116, v117
    v_cvt_pk_bf16_f32 v115, v118, v119
    ds_write_b128 v6, v[112:115] offset:4096
    v_cvt_pk_bf16_f32 v120, v120, v121
    v_cvt_pk_bf16_f32 v121, v122, v123
    v_cvt_pk_bf16_f32 v122, v124, v125
    v_cvt_pk_bf16_f32 v123, v126, v127
    ds_write_b128 v7, v[120:123] offset:4096
    v_pk_mul_f32 v[128:129], v[128:129], v[240:241] op_sel_hi:[1,0]
    v_pk_mul_f32 v[130:131], v[130:131], v[240:241] op_sel_hi:[1,0]
    v_pk_mul_f32 v[132:133], v[132:133], v[240:241] op_sel_hi:[1,0]
    v_pk_mul_f32 v[134:135], v[134:135], v[240:241] op_sel_hi:[1,0]
    v_pk_mul_f32 v[136:137], v[136:137], v[240:241] op_sel_hi:[1,0]
    v_pk_mul_f32 v[138:139], v[138:139], v[240:241] op_sel_hi:[1,0]
    v_pk_mul_f32 v[140:141], v[140:141], v[240:241] op_sel_hi:[1,0]
    v_pk_mul_f32 v[142:143], v[142:143], v[240:241] op_sel_hi:[1,0]
    v_cvt_pk_bf16_f32 v128, v128, v129
    v_cvt_pk_bf16_f32 v129, v130, v131
    v_cvt_pk_bf16_f32 v130, v132, v133
    v_cvt_pk_bf16_f32 v131, v134, v135
    ds_write_b128 v6, v[128:131] offset:4224
    v_cvt_pk_bf16_f32 v136, v136, v137
    v_cvt_pk_bf16_f32 v137, v138, v139
    v_cvt_pk_bf16_f32 v138, v140, v141
    v_cvt_pk_bf16_f32 v139, v142, v143
    ds_write_b128 v7, v[136:139] offset:4224
    ds_read_b128 v[116:119], v8 offset:4096
    ds_read_b128 v[124:127], v252 offset:5120
    ds_read_b128 v[132:135], v8 offset:6144
    ds_read_b128 v[140:143], v252 offset:7168
    s_waitcnt lgkmcnt(3)
    buffer_store_dwordx4 v[116:119], v255, s[24:27], s99 offen offset:0 sc0 sc1
    s_waitcnt lgkmcnt(2)
    buffer_store_dwordx4 v[124:127], v255, s[24:27], s99 offen offset:1024 sc0 sc1
    s_waitcnt lgkmcnt(1)
    buffer_store_dwordx4 v[132:135], v255, s[24:27], s99 offen offset:2048 sc0 sc1
    s_waitcnt lgkmcnt(0)
    buffer_store_dwordx4 v[140:143], v255, s[24:27], s99 offen offset:3072 sc0 sc1
    s_or_b64 s[88:89], s[50:51], s[52:53]
    s_cmp_lg_u64 s[88:89], 0
    s_cbranch_scc0 L_end
    s_waitcnt vmcnt(0) lgkmcnt(0)
    s_mov_b32 s18, 131072
    s_mov_b32 s22, 131072
    s_nop 15
    s_cmp_lg_u64 s[50:51], 0
    s_cselect_b32 s80, 0, 4
    s_cmp_lg_u64 s[52:53], 0
    s_cselect_b32 s81, 5, 4
    s_cmp_lg_u32 s46, 0
    s_cselect_b32 s81, 4, s81
    s_mov_b32 s86, 0x3e0293ee
    v_and_b32 v7, 15, v0
    v_lshrrev_b32 v8, 4, v0
    v_lshlrev_b32 v3, 8, v7
    v_lshl_add_u32 v1, v8, 4, v3
    v_lshl_add_u32 v3, v8, 3, v3
    v_lshlrev_b32 v2, 10, v8
    v_lshl_add_u32 v2, v7, 1, v2
    v_xor_b32 v4, 16, v0
    v_lshlrev_b32 v4, 2, v4
    v_xor_b32 v5, 32, v0
    v_lshlrev_b32 v5, 2, v5
    v_mov_b32 v80, 0x3f803f80
    v_mov_b32 v81, 0x3f803f80
    v_mov_b32 v82, 0x3f803f80
    v_mov_b32 v83, 0x3f803f80
L_sblk:
    s_cmp_ge_u32 s80, s81
    s_cbranch_scc1 L_end
    s_lshl_b32 s82, s30, 14
    s_lshl_b32 s88, s80, 12
    s_add_u32 s82, s82, s88
    s_lshr_b32 s88, s30, 1
    s_lshl_b32 s88, s88, 12
    s_add_u32 s88, s88, 65536
    s_cmp_eq_u32 s80, 4
    s_cselect_b32 s82, s88, s82
    buffer_load_dwordx4 v[16:19], v1, s[12:15], s82 offen offset:0
    buffer_load_dwordx4 v[20:23], v1, s[12:15], s82 offen offset:64
    buffer_load_dwordx4 v[24:27], v1, s[12:15], s82 offen offset:128
    buffer_load_dwordx4 v[28:31], v1, s[12:15], s82 offen offset:192
    v_mov_b32 v6, 0xff800000
    s_mov_b32 s83, 0
L_sp1:
    buffer_load_dwordx4 v[32:35], v1, s[16:19], s83 offen offset:0
    buffer_load_dwordx4 v[36:39], v1, s[16:19], s83 offen offset:64
    buffer_load_dwordx4 v[40:43], v1, s[16:19], s83 offen offset:128
    buffer_load_dwordx4 v[44:47], v1, s[16:19], s83 offen offset:192
    s_waitcnt vmcnt(0)
    v_mfma_f32_16x16x32_bf16 v[64:67], v[32:35], v[16:19], 0
    v_mfma_f32_16x16x32_bf16 v[64:67], v[36:39], v[20:23], v[64:67]
    v_mfma_f32_16x16x32_bf16 v[64:67], v[40:43], v[24:27], v[64:67]
    v_mfma_f32_16x16x32_bf16 v[64:67], v[44:47], v[28:31], v[64:67]
    s_nop 15
    v_max3_f32 v6, v64, v65, v6
    v_max3_f32 v6, v66, v67, v6
    s_add_u32 s83, s83, 4096
    s_cmp_lt_u32 s83, 131072
    s_nop 15
    s_cbranch_scc1 L_sp1
    ds_bpermute_b32 v7, v4, v6
    s_waitcnt lgkmcnt(0)
    v_max_f32 v6, v6, v7
    s_nop 15
    ds_bpermute_b32 v7, v5, v6
    s_waitcnt lgkmcnt(0)
    v_max_f32 v6, v6, v7
    s_nop 15
    v_mul_f32 v6, s86, v6
    v_sub_f32 v6, 0, v6
    v_mov_b32 v76, 0
    v_mov_b32 v77, 0
    v_mov_b32 v78, 0
    v_mov_b32 v79, 0
    v_mov_b32 v96, 0
    v_mov_b32 v97, 0
    v_mov_b32 v98, 0
    v_mov_b32 v99, 0
    v_mov_b32 v100, 0
    v_mov_b32 v101, 0
    v_mov_b32 v102, 0
    v_mov_b32 v103, 0
    v_mov_b32 v104, 0
    v_mov_b32 v105, 0
    v_mov_b32 v106, 0
    v_mov_b32 v107, 0
    v_mov_b32 v108, 0
    v_mov_b32 v109, 0
    v_mov_b32 v110, 0
    v_mov_b32 v111, 0
    v_mov_b32 v112, 0
    v_mov_b32 v113, 0
    v_mov_b32 v114, 0
    v_mov_b32 v115, 0
    v_mov_b32 v116, 0
    v_mov_b32 v117, 0
    v_mov_b32 v118, 0
    v_mov_b32 v119, 0
    v_mov_b32 v120, 0
    v_mov_b32 v121, 0
    v_mov_b32 v122, 0
    v_mov_b32 v123, 0
    v_mov_b32 v124, 0
    v_mov_b32 v125, 0
    v_mov_b32 v126, 0
    v_mov_b32 v127, 0
    s_mov_b32 s83, 0
L_sp2:
    s_add_u32 s84, s83, 4096
    buffer_load_dwordx4 v[32:35], v1, s[16:19], s83 offen offset:0
    buffer_load_dwordx4 v[36:39], v1, s[16:19], s83 offen offset:64
    buffer_load_dwordx4 v[40:43], v1, s[16:19], s83 offen offset:128
    buffer_load_dwordx4 v[44:47], v1, s[16:19], s83 offen offset:192
    buffer_load_dwordx4 v[48:51], v1, s[16:19], s84 offen offset:0
    buffer_load_dwordx4 v[52:55], v1, s[16:19], s84 offen offset:64
    buffer_load_dwordx4 v[56:59], v1, s[16:19], s84 offen offset:128
    buffer_load_dwordx4 v[60:63], v1, s[16:19], s84 offen offset:192
    buffer_load_ushort v128, v2, s[20:23], s83 offen offset:0
    buffer_load_ushort v129, v2, s[20:23], s83 offen offset:256
    buffer_load_ushort v130, v2, s[20:23], s83 offen offset:512
    buffer_load_ushort v131, v2, s[20:23], s83 offen offset:768
    buffer_load_ushort v132, v2, s[20:23], s84 offen offset:0
    buffer_load_ushort v133, v2, s[20:23], s84 offen offset:256
    buffer_load_ushort v134, v2, s[20:23], s84 offen offset:512
    buffer_load_ushort v135, v2, s[20:23], s84 offen offset:768
    buffer_load_ushort v136, v2, s[20:23], s83 offen offset:32
    buffer_load_ushort v137, v2, s[20:23], s83 offen offset:288
    buffer_load_ushort v138, v2, s[20:23], s83 offen offset:544
    buffer_load_ushort v139, v2, s[20:23], s83 offen offset:800
    buffer_load_ushort v140, v2, s[20:23], s84 offen offset:32
    buffer_load_ushort v141, v2, s[20:23], s84 offen offset:288
    buffer_load_ushort v142, v2, s[20:23], s84 offen offset:544
    buffer_load_ushort v143, v2, s[20:23], s84 offen offset:800
    buffer_load_ushort v144, v2, s[20:23], s83 offen offset:64
    buffer_load_ushort v145, v2, s[20:23], s83 offen offset:320
    buffer_load_ushort v146, v2, s[20:23], s83 offen offset:576
    buffer_load_ushort v147, v2, s[20:23], s83 offen offset:832
    buffer_load_ushort v148, v2, s[20:23], s84 offen offset:64
    buffer_load_ushort v149, v2, s[20:23], s84 offen offset:320
    buffer_load_ushort v150, v2, s[20:23], s84 offen offset:576
    buffer_load_ushort v151, v2, s[20:23], s84 offen offset:832
    buffer_load_ushort v152, v2, s[20:23], s83 offen offset:96
    buffer_load_ushort v153, v2, s[20:23], s83 offen offset:352
    buffer_load_ushort v154, v2, s[20:23], s83 offen offset:608
    buffer_load_ushort v155, v2, s[20:23], s83 offen offset:864
    buffer_load_ushort v156, v2, s[20:23], s84 offen offset:96
    buffer_load_ushort v157, v2, s[20:23], s84 offen offset:352
    buffer_load_ushort v158, v2, s[20:23], s84 offen offset:608
    buffer_load_ushort v159, v2, s[20:23], s84 offen offset:864
    s_waitcnt vmcnt(0)
    buffer_load_ushort v160, v2, s[20:23], s83 offen offset:128
    buffer_load_ushort v161, v2, s[20:23], s83 offen offset:384
    buffer_load_ushort v162, v2, s[20:23], s83 offen offset:640
    buffer_load_ushort v163, v2, s[20:23], s83 offen offset:896
    buffer_load_ushort v164, v2, s[20:23], s84 offen offset:128
    buffer_load_ushort v165, v2, s[20:23], s84 offen offset:384
    buffer_load_ushort v166, v2, s[20:23], s84 offen offset:640
    buffer_load_ushort v167, v2, s[20:23], s84 offen offset:896
    buffer_load_ushort v168, v2, s[20:23], s83 offen offset:160
    buffer_load_ushort v169, v2, s[20:23], s83 offen offset:416
    buffer_load_ushort v170, v2, s[20:23], s83 offen offset:672
    buffer_load_ushort v171, v2, s[20:23], s83 offen offset:928
    buffer_load_ushort v172, v2, s[20:23], s84 offen offset:160
    buffer_load_ushort v173, v2, s[20:23], s84 offen offset:416
    buffer_load_ushort v174, v2, s[20:23], s84 offen offset:672
    buffer_load_ushort v175, v2, s[20:23], s84 offen offset:928
    buffer_load_ushort v176, v2, s[20:23], s83 offen offset:192
    buffer_load_ushort v177, v2, s[20:23], s83 offen offset:448
    buffer_load_ushort v178, v2, s[20:23], s83 offen offset:704
    buffer_load_ushort v179, v2, s[20:23], s83 offen offset:960
    buffer_load_ushort v180, v2, s[20:23], s84 offen offset:192
    buffer_load_ushort v181, v2, s[20:23], s84 offen offset:448
    buffer_load_ushort v182, v2, s[20:23], s84 offen offset:704
    buffer_load_ushort v183, v2, s[20:23], s84 offen offset:960
    buffer_load_ushort v184, v2, s[20:23], s83 offen offset:224
    buffer_load_ushort v185, v2, s[20:23], s83 offen offset:480
    buffer_load_ushort v186, v2, s[20:23], s83 offen offset:736
    buffer_load_ushort v187, v2, s[20:23], s83 offen offset:992
    buffer_load_ushort v188, v2, s[20:23], s84 offen offset:224
    buffer_load_ushort v189, v2, s[20:23], s84 offen offset:480
    buffer_load_ushort v190, v2, s[20:23], s84 offen offset:736
    buffer_load_ushort v191, v2, s[20:23], s84 offen offset:992
    s_waitcnt vmcnt(0)
    v_lshl_or_b32 v192, v129, 16, v128
    v_lshl_or_b32 v193, v131, 16, v130
    v_lshl_or_b32 v194, v133, 16, v132
    v_lshl_or_b32 v195, v135, 16, v134
    v_lshl_or_b32 v196, v137, 16, v136
    v_lshl_or_b32 v197, v139, 16, v138
    v_lshl_or_b32 v198, v141, 16, v140
    v_lshl_or_b32 v199, v143, 16, v142
    v_lshl_or_b32 v200, v145, 16, v144
    v_lshl_or_b32 v201, v147, 16, v146
    v_lshl_or_b32 v202, v149, 16, v148
    v_lshl_or_b32 v203, v151, 16, v150
    v_lshl_or_b32 v204, v153, 16, v152
    v_lshl_or_b32 v205, v155, 16, v154
    v_lshl_or_b32 v206, v157, 16, v156
    v_lshl_or_b32 v207, v159, 16, v158
    v_lshl_or_b32 v208, v161, 16, v160
    v_lshl_or_b32 v209, v163, 16, v162
    v_lshl_or_b32 v210, v165, 16, v164
    v_lshl_or_b32 v211, v167, 16, v166
    v_lshl_or_b32 v212, v169, 16, v168
    v_lshl_or_b32 v213, v171, 16, v170
    v_lshl_or_b32 v214, v173, 16, v172
    v_lshl_or_b32 v215, v175, 16, v174
    v_lshl_or_b32 v216, v177, 16, v176
    v_lshl_or_b32 v217, v179, 16, v178
    v_lshl_or_b32 v218, v181, 16, v180
    v_lshl_or_b32 v219, v183, 16, v182
    v_lshl_or_b32 v220, v185, 16, v184
    v_lshl_or_b32 v221, v187, 16, v186
    v_lshl_or_b32 v222, v189, 16, v188
    v_lshl_or_b32 v223, v191, 16, v190
    v_mfma_f32_16x16x32_bf16 v[64:67], v[32:35], v[16:19], 0
    v_mfma_f32_16x16x32_bf16 v[64:67], v[36:39], v[20:23], v[64:67]
    v_mfma_f32_16x16x32_bf16 v[64:67], v[40:43], v[24:27], v[64:67]
    v_mfma_f32_16x16x32_bf16 v[64:67], v[44:47], v[28:31], v[64:67]
    v_mfma_f32_16x16x32_bf16 v[68:71], v[48:51], v[16:19], 0
    v_mfma_f32_16x16x32_bf16 v[68:71], v[52:55], v[20:23], v[68:71]
    v_mfma_f32_16x16x32_bf16 v[68:71], v[56:59], v[24:27], v[68:71]
    v_mfma_f32_16x16x32_bf16 v[68:71], v[60:63], v[28:31], v[68:71]
    s_nop 15
    v_fma_f32 v64, v64, s86, v6
    v_fma_f32 v65, v65, s86, v6
    v_fma_f32 v66, v66, s86, v6
    v_fma_f32 v67, v67, s86, v6
    v_fma_f32 v68, v68, s86, v6
    v_fma_f32 v69, v69, s86, v6
    v_fma_f32 v70, v70, s86, v6
    v_fma_f32 v71, v71, s86, v6
    v_exp_f32 v64, v64
    v_exp_f32 v65, v65
    v_exp_f32 v66, v66
    v_exp_f32 v67, v67
    v_exp_f32 v68, v68
    v_exp_f32 v69, v69
    v_exp_f32 v70, v70
    v_exp_f32 v71, v71
    s_nop 1
    v_cvt_pk_bf16_f32 v72, v64, v65
    v_cvt_pk_bf16_f32 v73, v66, v67
    v_cvt_pk_bf16_f32 v74, v68, v69
    v_cvt_pk_bf16_f32 v75, v70, v71
    s_nop 3
    v_mfma_f32_16x16x32_bf16 v[76:79], v[80:83], v[72:75], v[76:79]
    v_mfma_f32_16x16x32_bf16 v[96:99], v[192:195], v[72:75], v[96:99]
    v_mfma_f32_16x16x32_bf16 v[100:103], v[196:199], v[72:75], v[100:103]
    v_mfma_f32_16x16x32_bf16 v[104:107], v[200:203], v[72:75], v[104:107]
    v_mfma_f32_16x16x32_bf16 v[108:111], v[204:207], v[72:75], v[108:111]
    v_mfma_f32_16x16x32_bf16 v[112:115], v[208:211], v[72:75], v[112:115]
    v_mfma_f32_16x16x32_bf16 v[116:119], v[212:215], v[72:75], v[116:119]
    v_mfma_f32_16x16x32_bf16 v[120:123], v[216:219], v[72:75], v[120:123]
    v_mfma_f32_16x16x32_bf16 v[124:127], v[220:223], v[72:75], v[124:127]
    s_add_u32 s83, s83, 8192
    s_cmp_lt_u32 s83, 131072
    s_nop 15
    s_cbranch_scc1 L_sp2
    v_rcp_f32 v7, v76
    s_nop 1
    v_mul_f32 v96, v96, v7
    v_mul_f32 v97, v97, v7
    v_mul_f32 v98, v98, v7
    v_mul_f32 v99, v99, v7
    v_mul_f32 v100, v100, v7
    v_mul_f32 v101, v101, v7
    v_mul_f32 v102, v102, v7
    v_mul_f32 v103, v103, v7
    v_mul_f32 v104, v104, v7
    v_mul_f32 v105, v105, v7
    v_mul_f32 v106, v106, v7
    v_mul_f32 v107, v107, v7
    v_mul_f32 v108, v108, v7
    v_mul_f32 v109, v109, v7
    v_mul_f32 v110, v110, v7
    v_mul_f32 v111, v111, v7
    v_mul_f32 v112, v112, v7
    v_mul_f32 v113, v113, v7
    v_mul_f32 v114, v114, v7
    v_mul_f32 v115, v115, v7
    v_mul_f32 v116, v116, v7
    v_mul_f32 v117, v117, v7
    v_mul_f32 v118, v118, v7
    v_mul_f32 v119, v119, v7
    v_mul_f32 v120, v120, v7
    v_mul_f32 v121, v121, v7
    v_mul_f32 v122, v122, v7
    v_mul_f32 v123, v123, v7
    v_mul_f32 v124, v124, v7
    v_mul_f32 v125, v125, v7
    v_mul_f32 v126, v126, v7
    v_mul_f32 v127, v127, v7
    v_cvt_pk_bf16_f32 v192, v96, v97
    v_cvt_pk_bf16_f32 v193, v98, v99
    v_cvt_pk_bf16_f32 v194, v100, v101
    v_cvt_pk_bf16_f32 v195, v102, v103
    v_cvt_pk_bf16_f32 v196, v104, v105
    v_cvt_pk_bf16_f32 v197, v106, v107
    v_cvt_pk_bf16_f32 v198, v108, v109
    v_cvt_pk_bf16_f32 v199, v110, v111
    v_cvt_pk_bf16_f32 v200, v112, v113
    v_cvt_pk_bf16_f32 v201, v114, v115
    v_cvt_pk_bf16_f32 v202, v116, v117
    v_cvt_pk_bf16_f32 v203, v118, v119
    v_cvt_pk_bf16_f32 v204, v120, v121
    v_cvt_pk_bf16_f32 v205, v122, v123
    v_cvt_pk_bf16_f32 v206, v124, v125
    v_cvt_pk_bf16_f32 v207, v126, v127
    s_nop 1
    buffer_store_dwordx2 v[192:193], v3, s[24:27], s82 offen offset:0
    buffer_store_dwordx2 v[194:195], v3, s[24:27], s82 offen offset:32
    buffer_store_dwordx2 v[196:197], v3, s[24:27], s82 offen offset:64
    buffer_store_dwordx2 v[198:199], v3, s[24:27], s82 offen offset:96
    buffer_store_dwordx2 v[200:201], v3, s[24:27], s82 offen offset:128
    buffer_store_dwordx2 v[202:203], v3, s[24:27], s82 offen offset:160
    buffer_store_dwordx2 v[204:205], v3, s[24:27], s82 offen offset:192
    buffer_store_dwordx2 v[206:207], v3, s[24:27], s82 offen offset:224
    s_waitcnt vmcnt(0)
    s_add_u32 s80, s80, 1
    s_nop 15
    s_branch L_sblk
L_end:
    s_endpgm
L_xskip:
    s_waitcnt lgkmcnt(0)
    s_nop 1
    s_branch L_xret
    s_endpgm

.section .rodata,"a"
.p2align 6
.amdhsa_kernel standalone__gqa_softmax__near_ridge_kernel
  .amdhsa_next_free_vgpr 492
  .amdhsa_next_free_sgpr 102
  .amdhsa_accum_offset 256
  .amdhsa_group_segment_fixed_size 0
  .amdhsa_kernarg_size 48
  .amdhsa_user_sgpr_count 2
  .amdhsa_user_sgpr_kernarg_segment_ptr 1
  .amdhsa_system_sgpr_workgroup_id_x 1
.end_amdhsa_kernel
```
